```python
import torch

def _softmax(x, axis=-1):
    return torch.softmax(x, dim=axis)
def _gelu(x):
    return torch.nn.functional.gelu(x, approximate="tanh")
def _silu(x):
    return torch.nn.functional.silu(x)
def _sigmoid(x):
    return torch.sigmoid(x)
def _layernorm(x, axis=-1, eps=1e-5):
    m = x.mean(dim=axis, keepdim=True)
    v = x.var(dim=axis, keepdim=True, unbiased=False)
    return (x - m) / torch.sqrt(v + eps)
def _scatter_add(tgt, idx, src, axis=0):
    return tgt.clone().index_add_(axis, idx, src)
def _segment_sum(src, seg, n):
    out = torch.zeros((n,) + src.shape[1:], dtype=src.dtype)
    return out.index_add_(0, seg, src)
def _pad(x, pw):
    flat = tuple(v for pair in reversed(pw) for v in pair)
    return torch.nn.functional.pad(x, flat)

kernel_name = 'gated_mix__softmax_full_mha__dense_activation_squared_relu__prompt'

def setup_inputs():

    _w = (lambda a: (lambda t: t.to(torch.bfloat16) if t.is_floating_point() else t)(torch.as_tensor(a)))
    def _A_setup():
        B, S, D = 1, 2048, 512
        return {
            "x": _w((lambda *s: torch.randn(*s, dtype=torch.bfloat16) * 0.05)(B, S, D)),
            "wqkv": _w((lambda *s: torch.randn(*s, dtype=torch.bfloat16) * 0.8)(D, 3 * D)),
            "wo": _w((lambda *s: torch.randn(*s, dtype=torch.bfloat16) * 0.1)(D, D)),
        }
    _A_in = _A_setup()

    def _B_setup():
        B, S, D, F = 1, 2048, 512, 1376
        return {
            "x": _w((lambda *s: torch.randn(*s, dtype=torch.bfloat16) * 0.05)(B, S, D)),
            "w1": _w((lambda *s: torch.randn(*s, dtype=torch.bfloat16) * 0.1)(D, F)),
            "b1": _w((lambda *s: torch.randn(*s, dtype=torch.bfloat16) * 0.1)(F)),
            "w2": _w((lambda *s: torch.randn(*s, dtype=torch.bfloat16) * 0.1)(F, D)),
            "b2": _w((lambda *s: torch.randn(*s, dtype=torch.bfloat16) * 0.05)(D)),
        }
    _B_in = _B_setup()

    return {
        "A_x": _A_in["x"],
        "A_wqkv": _A_in["wqkv"],
        "A_wo": _A_in["wo"],
        "B_x": _B_in["x"],
        "B_w1": _B_in["w1"],
        "B_b1": _B_in["b1"],
        "B_w2": _B_in["w2"],
        "B_b2": _B_in["b2"],
        "gate_w": _w((lambda *s: torch.randn(*s, dtype=torch.bfloat16) * 0.05)(512) * 16.0),
    }

def reference(A_x, A_wqkv, A_wo, B_x, B_w1, B_b1, B_w2, B_b2, gate_w):
    def _A_ref(x, wqkv, wo):
        B, S, D = x.shape
        H = 32; Dh = D // H
        qkv = (lambda x, *d: x.permute(*d))((x @ wqkv).reshape(B, S, 3, H, Dh), 2, 0, 3, 1, 4)
        q, k, v = qkv[0], qkv[1], qkv[2]
        scale = Dh ** -0.5
        scores = torch.einsum("bhqd,bhkd->bhqk", q, k) * scale
        p = _softmax(scores, axis=-1)
        o = torch.einsum("bhqk,bhkd->bhqd", p, v)
        return (lambda x, *d: x.permute(*d))(o, 0, 2, 1, 3).reshape(B, S, D) @ wo

    def _B_ref(x, w1, b1, w2, b2):
        h = torch.einsum("bsd,df->bsf", x, w1) + b1
        zero = torch.zeros_like(h)
        r = torch.where(h > zero, h, zero)
        h = r * r
        out = torch.einsum("bsf,fd->bsd", h, w2) + b2
        return out

    x = A_x
    g = _sigmoid((x * gate_w).sum(-1, keepdims=True))
    a = _A_ref(x, A_wqkv, A_wo)
    b = _B_ref(x, B_w1, B_b1, B_w2, B_b2)
    return g * a + (1 - g) * b
```

```asm
; @launch grid=(256,1,1) block=(768,1,1) lds=163840
.amdgcn_target "amdgcn-amd-amdhsa--gfx950"
.text
.globl gated_mix__softmax_full_mha__dense_activation_squared_relu__prompt_kernel
.p2align 8
.type gated_mix__softmax_full_mha__dense_activation_squared_relu__prompt_kernel,@function
gated_mix__softmax_full_mha__dense_activation_squared_relu__prompt_kernel:
    s_lshr_b32 s3, s2, 8
    s_cbranch_scc1 L_exit
    s_load_dwordx2 s[4:5], s[0:1], 0
    s_load_dwordx2 s[32:33], s[0:1], 64
    s_getpc_b64 s[96:97]
L_pc0:
    v_cmp_gt_u32 vcc, 64, v0
    s_lshl_b32 s98, s2, 4
    s_cbranch_vccz L_nopf
    v_lshl_add_u32 v145, v0, 10, s98
    v_min_u32 v145, L_end-L_pc0, v145
    global_load_dword v144, v145, s[96:97]
    s_and_b32 s98, s2, 3
    s_mul_i32 s98, s98, 0x7ff80
    s_lshr_b32 s99, s2, 3
    s_lshl_b32 s99, s99, 14
    v_lshl_add_u32 v147, v0, 8, s98
    v_add_u32 v147, s99, v147
    s_waitcnt lgkmcnt(0)
    global_load_dword v146, v147, s[4:5]
L_nopf:
    s_load_dwordx2 s[8:9], s[0:1], 8
    s_load_dwordx2 s[24:25], s[0:1], 40
    s_load_dwordx2 s[44:45], s[0:1], 88
    v_lshrrev_b32 v1, 6, v0
    v_and_b32 v165, 63, v0
    s_mov_b32 s6, 2097152
    s_mov_b32 s7, 0x20000
    s_mov_b32 s10, 1572864
    s_mov_b32 s11, s7
    s_mov_b32 s34, 1024
    s_mov_b32 s35, s7
    s_mov_b32 s26, 2752
    s_mov_b32 s27, s7
    s_mov_b32 s46, 268435456
    s_mov_b32 s47, s7
    v_readfirstlane_b32 s48, v1
    s_and_b32 s53, s2, 3
    s_lshl_b32 s53, s53, 2
    s_bfe_u32 s54, s2, 0x20003
    s_add_u32 s50, s53, s54
    s_bfe_u32 s53, s2, 0x10002
    s_lshr_b32 s54, s2, 5
    s_lshl_b32 s53, s53, 3
    s_add_u32 s49, s53, s54
    s_add_u32 s53, s50, s49
    s_and_b32 s53, s53, 1
    s_lshl_b32 s53, s53, 2
    s_and_b32 s54, s2, 3
    s_add_u32 s51, s53, s54
    s_and_b32 s52, s48, 3
    s_mov_b32 s60, 0xffff
    s_mov_b32 s61, 0xffff
    v_and_b32 v1, 31, v165
    v_lshrrev_b32 v2, 5, v165
    v_bfe_u32 v3, v165, 1, 3
    v_xor_b32 v3, v3, v2
    v_lshlrev_b32 v3, 4, v3
    v_lshl_add_u32 v3, v1, 7, v3
    s_lshl_b32 s53, s52, 12
    v_add_u32 v160, s53, v3
    s_cmp_lt_u32 s48, 8
    s_cbranch_scc1 L_roleKV
    v_lshrrev_b32 v166, 2, v165
    s_lshl_b32 s53, s52, 4
    v_add_u32 v166, s53, v166
    v_and_b32 v167, 3, v165
    s_lshl_b32 s53, s49, 6
    v_mul_u32_u24 v166, 3072, v166
    v_lshl_add_u32 v167, v167, 4, s53
    v_add_u32 v162, v166, v167
    s_lshl_b32 s59, s52, 10
    s_lshl_b32 s56, s48, 10
    s_mov_b32 s55, 2
    v_lshlrev_b32 v1, 2, v165
    v_add_u32 v2, 163584, v1
    v_mov_b32 v3, 0
    s_lshl_b32 s53, s51, 7
    v_lshl_add_u32 v4, v165, 4, s53
    v_and_b32 v4, 1023, v4
    s_mul_i32 s53, s49, 192
    v_add_u32 v5, s53, v1
    v_lshlrev_b32 v6, 8, v165
    s_waitcnt lgkmcnt(0)
    s_cmp_lg_u32 s48, 11
    s_cbranch_scc1 L_q1
    s_cmp_lg_u32 s2, 0
    s_cbranch_scc1 L_q0
    s_mov_b32 exec_hi, 0
    buffer_store_dword v3, v6, s[44:47], 0 offen sc1
    s_mov_b64 exec, -1
L_q0:
    ds_write_b32 v2, v3
    s_mov_b32 m0, 161792
    s_nop 0
    buffer_load_dwordx4 v4, s[32:35], 0 offen lds
    s_mov_b32 m0, 162816
    s_nop 0
    buffer_load_dword v5, s[24:27], 0 offen lds
L_q1:
    s_add_u32 s53, s51, 0
    s_and_b32 s53, s53, 7
    s_mul_i32 s53, s53, 196608
    s_add_u32 m0, s59, 24576
    s_nop 0
    buffer_load_dwordx4 v162, s[8:11], s53 offen lds
    s_barrier
    s_add_u32 s53, s51, 1
    s_and_b32 s53, s53, 7
    s_mul_i32 s53, s53, 196608
    s_add_u32 m0, s59, 53248
    s_nop 0
    buffer_load_dwordx4 v162, s[8:11], s53 offen lds
    s_branch L_roleQ
L_roleKV:
    v_lshrrev_b32 v1, 3, v165
    s_lshl_b32 s53, s50, 7
    s_lshl_b32 s54, s48, 4
    s_add_u32 s53, s53, s54
    v_add_u32 v4, s53, v1
    v_lshlrev_b32 v4, 10, v4
    v_and_b32 v2, 7, v165
    v_lshrrev_b32 v3, 4, v165
    v_xor_b32 v5, v2, v3
    v_lshl_add_u32 v162, v5, 4, v4
    v_xor_b32 v163, 64, v162
    v_add_u32 v163, 8192, v163
    s_lshl_b32 s59, s48, 11
    s_lshl_b32 s56, s48, 10
    s_lshl_b32 s53, s48, 3
    v_add_u32 v1, s53, v1
    v_mul_u32_u24 v1, 3072, v1
    v_and_b32 v3, 1, v3
    v_lshlrev_b32 v3, 2, v3
    v_xor_b32 v2, v2, v3
    v_lshl_add_u32 v1, v2, 4, v1
    s_and_b32 s57, s49, 1
    s_lshl_b32 s53, s57, 10
    s_lshr_b32 s58, s49, 1
    s_lshl_b32 s54, s58, 7
    s_add_u32 s53, s53, s54
    s_add_u32 s53, s53, 1024
    v_add_u32 v164, s53, v1
    s_lshr_b32 s55, s48, 2
    s_waitcnt lgkmcnt(0)
    s_add_u32 s53, s51, 0
    s_and_b32 s53, s53, 7
    s_mul_i32 s53, s53, 128
    s_add_u32 m0, s59, 0
    s_nop 0
    buffer_load_dwordx4 v162, s[4:7], s53 offen lds
    s_add_u32 m0, s59, 1024
    s_mul_i32 s54, s53, 1536
    buffer_load_dwordx4 v163, s[4:7], s53 offen lds
    s_add_u32 m0, s56, 16384
    s_nop 0
    buffer_load_dwordx4 v164, s[8:11], s54 offen lds
    s_barrier
    s_add_u32 s53, s51, 1
    s_and_b32 s53, s53, 7
    s_mul_i32 s53, s53, 128
    s_add_u32 m0, s59, 28672
    s_nop 0
    buffer_load_dwordx4 v162, s[4:7], s53 offen lds
    s_add_u32 m0, s59, 29696
    s_mul_i32 s54, s53, 1536
    buffer_load_dwordx4 v163, s[4:7], s53 offen lds
    s_add_u32 m0, s56, 45056
    s_nop 0
    buffer_load_dwordx4 v164, s[8:11], s54 offen lds
    s_load_dwordx2 s[40:41], s[0:1], 80
    s_load_dwordx2 s[12:13], s[0:1], 32
    s_load_dwordx2 s[20:21], s[0:1], 16
    s_load_dwordx2 s[16:17], s[0:1], 48
    s_load_dwordx2 s[28:29], s[0:1], 56
    s_load_dwordx2 s[36:37], s[0:1], 72
    s_mov_b32 s42, 256
    s_mov_b32 s43, s7
    s_mov_b32 s14, 1409024
    s_mov_b32 s15, s7
    s_mov_b32 s22, 524288
    s_mov_b32 s23, s7
    s_mov_b32 s18, 1409024
    s_mov_b32 s19, s7
    s_mov_b32 s30, 1024
    s_mov_b32 s31, s7
    s_mov_b32 s38, 2097152
    s_mov_b32 s39, s7
    v_lshrrev_b32 v1, 5, v165
    v_bfe_u32 v2, v165, 2, 2
    v_lshl_add_u32 v1, v1, 3, v2
    v_lshlrev_b32 v1, 7, v1
    v_bfe_u32 v2, v165, 4, 1
    v_lshl_add_u32 v1, v2, 5, v1
    v_and_b32 v2, 3, v165
    v_lshl_add_u32 v1, v2, 3, v1
    v_bfe_u32 v2, v165, 3, 1
    v_xor_b32 v2, s55, v2
    v_lshl_add_u32 v1, v2, 6, v1
    v_add_u32 v161, 16384, v1
    s_waitcnt lgkmcnt(0)
    s_cmp_lg_u32 s57, 0
    s_cbranch_scc1 L_roleV
    s_waitcnt vmcnt(3)
    s_barrier
    ds_read_b64_tr_b16 v[144:145], v161 offset:0
    ds_read_b64_tr_b16 v[146:147], v161 offset:512
    ds_read_b128 v[0:3], v160 offset:0
    v_xor_b32 v160, 32, v160
    s_add_u32 s53, s51, 2
    s_and_b32 s53, s53, 7
    s_mul_i32 s53, s53, 128
    s_add_u32 m0, s59, 57344
    s_nop 0
    buffer_load_dwordx4 v162, s[4:7], s53 offen lds
    ds_read_b64_tr_b16 v[148:149], v161 offset:2048
    ds_read_b64_tr_b16 v[150:151], v161 offset:2560
    ds_read_b128 v[4:7], v160 offset:0
    v_xor_b32 v160, 96, v160
    s_add_u32 m0, s59, 58368
    s_mul_i32 s54, s53, 1536
    buffer_load_dwordx4 v163, s[4:7], s53 offen lds
    ds_read_b64_tr_b16 v[152:153], v161 offset:4096
    ds_read_b64_tr_b16 v[154:155], v161 offset:4608
    ds_read_b128 v[8:11], v160 offset:0
    v_xor_b32 v160, 32, v160
    s_add_u32 m0, s56, 73728
    s_nop 0
    buffer_load_dwordx4 v164, s[8:11], s54 offen lds
    ds_read_b64_tr_b16 v[156:157], v161 offset:6144
    ds_read_b64_tr_b16 v[158:159], v161 offset:6656
    ds_read_b128 v[12:15], v160 offset:0
    v_xor_b32 v160, 96, v160
    s_waitcnt lgkmcnt(0)
    s_waitcnt vmcnt(3)
    s_barrier
    v_mfma_f32_32x32x16_bf16 v[128:143], v[144:147], v[0:3], 0
    ds_read_b64_tr_b16 v[144:145], v161 offset:28672
    ds_read_b64_tr_b16 v[146:147], v161 offset:29184
    ds_read_b128 v[16:19], v160 offset:28672
    v_xor_b32 v160, 32, v160
    s_add_u32 s53, s51, 3
    s_and_b32 s53, s53, 7
    s_mul_i32 s53, s53, 128
    s_add_u32 m0, s59, 0
    s_nop 0
    buffer_load_dwordx4 v162, s[4:7], s53 offen lds
    v_mfma_f32_32x32x16_bf16 v[128:143], v[148:151], v[4:7], v[128:143]
    ds_read_b64_tr_b16 v[148:149], v161 offset:30720
    ds_read_b64_tr_b16 v[150:151], v161 offset:31232
    ds_read_b128 v[20:23], v160 offset:28672
    v_xor_b32 v160, 96, v160
    s_add_u32 m0, s59, 1024
    s_mul_i32 s54, s53, 1536
    buffer_load_dwordx4 v163, s[4:7], s53 offen lds
    v_mfma_f32_32x32x16_bf16 v[128:143], v[152:155], v[8:11], v[128:143]
    ds_read_b64_tr_b16 v[152:153], v161 offset:32768
    ds_read_b64_tr_b16 v[154:155], v161 offset:33280
    ds_read_b128 v[24:27], v160 offset:28672
    v_xor_b32 v160, 32, v160
    s_add_u32 m0, s56, 16384
    s_nop 0
    buffer_load_dwordx4 v164, s[8:11], s54 offen lds
    v_mfma_f32_32x32x16_bf16 v[128:143], v[156:159], v[12:15], v[128:143]
    ds_read_b64_tr_b16 v[156:157], v161 offset:34816
    ds_read_b64_tr_b16 v[158:159], v161 offset:35328
    ds_read_b128 v[28:31], v160 offset:28672
    v_xor_b32 v160, 96, v160
    s_waitcnt lgkmcnt(0)
    s_waitcnt vmcnt(3)
    s_barrier
    v_add_u32 v161, 57344, v161
    v_mfma_f32_32x32x16_bf16 v[128:143], v[144:147], v[16:19], v[128:143]
    ds_read_b64_tr_b16 v[144:145], v161 offset:0
    ds_read_b64_tr_b16 v[146:147], v161 offset:512
    ds_read_b128 v[32:35], v160 offset:57344
    v_xor_b32 v160, 32, v160
    s_add_u32 s53, s51, 4
    s_and_b32 s53, s53, 7
    s_mul_i32 s53, s53, 128
    s_add_u32 m0, s59, 28672
    s_nop 0
    buffer_load_dwordx4 v162, s[4:7], s53 offen lds
    v_mfma_f32_32x32x16_bf16 v[128:143], v[148:151], v[20:23], v[128:143]
    ds_read_b64_tr_b16 v[148:149], v161 offset:2048
    ds_read_b64_tr_b16 v[150:151], v161 offset:2560
    ds_read_b128 v[36:39], v160 offset:57344
    v_xor_b32 v160, 96, v160
    s_add_u32 m0, s59, 29696
    s_mul_i32 s54, s53, 1536
    buffer_load_dwordx4 v163, s[4:7], s53 offen lds
    v_mfma_f32_32x32x16_bf16 v[128:143], v[152:155], v[24:27], v[128:143]
    ds_read_b64_tr_b16 v[152:153], v161 offset:4096
    ds_read_b64_tr_b16 v[154:155], v161 offset:4608
    ds_read_b128 v[40:43], v160 offset:57344
    v_xor_b32 v160, 32, v160
    s_add_u32 m0, s56, 45056
    s_nop 0
    buffer_load_dwordx4 v164, s[8:11], s54 offen lds
    v_mfma_f32_32x32x16_bf16 v[128:143], v[156:159], v[28:31], v[128:143]
    ds_read_b64_tr_b16 v[156:157], v161 offset:6144
    ds_read_b64_tr_b16 v[158:159], v161 offset:6656
    ds_read_b128 v[44:47], v160 offset:57344
    v_xor_b32 v160, 96, v160
    s_waitcnt lgkmcnt(0)
    s_waitcnt vmcnt(3)
    s_barrier
    v_add_u32 v161, 4294909952, v161
    v_mfma_f32_32x32x16_bf16 v[128:143], v[144:147], v[32:35], v[128:143]
    ds_read_b64_tr_b16 v[144:145], v161 offset:0
    ds_read_b64_tr_b16 v[146:147], v161 offset:512
    ds_read_b128 v[48:51], v160 offset:0
    v_xor_b32 v160, 32, v160
    s_add_u32 s53, s51, 5
    s_and_b32 s53, s53, 7
    s_mul_i32 s53, s53, 128
    s_add_u32 m0, s59, 57344
    s_nop 0
    buffer_load_dwordx4 v162, s[4:7], s53 offen lds
    v_mfma_f32_32x32x16_bf16 v[128:143], v[148:151], v[36:39], v[128:143]
    ds_read_b64_tr_b16 v[148:149], v161 offset:2048
    ds_read_b64_tr_b16 v[150:151], v161 offset:2560
    ds_read_b128 v[52:55], v160 offset:0
    v_xor_b32 v160, 96, v160
    s_add_u32 m0, s59, 58368
    s_mul_i32 s54, s53, 1536
    buffer_load_dwordx4 v163, s[4:7], s53 offen lds
    v_mfma_f32_32x32x16_bf16 v[128:143], v[152:155], v[40:43], v[128:143]
    ds_read_b64_tr_b16 v[152:153], v161 offset:4096
    ds_read_b64_tr_b16 v[154:155], v161 offset:4608
    ds_read_b128 v[56:59], v160 offset:0
    v_xor_b32 v160, 32, v160
    s_add_u32 m0, s56, 73728
    s_nop 0
    buffer_load_dwordx4 v164, s[8:11], s54 offen lds
    v_mfma_f32_32x32x16_bf16 v[128:143], v[156:159], v[44:47], v[128:143]
    ds_read_b64_tr_b16 v[156:157], v161 offset:6144
    ds_read_b64_tr_b16 v[158:159], v161 offset:6656
    ds_read_b128 v[60:63], v160 offset:0
    v_xor_b32 v160, 96, v160
    s_waitcnt lgkmcnt(0)
    s_waitcnt vmcnt(3)
    s_barrier
    v_mfma_f32_32x32x16_bf16 v[128:143], v[144:147], v[48:51], v[128:143]
    ds_read_b64_tr_b16 v[144:145], v161 offset:28672
    ds_read_b64_tr_b16 v[146:147], v161 offset:29184
    ds_read_b128 v[64:67], v160 offset:28672
    v_xor_b32 v160, 32, v160
    s_add_u32 s53, s51, 6
    s_and_b32 s53, s53, 7
    s_mul_i32 s53, s53, 128
    s_add_u32 m0, s59, 0
    s_nop 0
    buffer_load_dwordx4 v162, s[4:7], s53 offen lds
    v_mfma_f32_32x32x16_bf16 v[128:143], v[148:151], v[52:55], v[128:143]
    ds_read_b64_tr_b16 v[148:149], v161 offset:30720
    ds_read_b64_tr_b16 v[150:151], v161 offset:31232
    ds_read_b128 v[68:71], v160 offset:28672
    v_xor_b32 v160, 96, v160
    s_add_u32 m0, s59, 1024
    s_mul_i32 s54, s53, 1536
    buffer_load_dwordx4 v163, s[4:7], s53 offen lds
    v_mfma_f32_32x32x16_bf16 v[128:143], v[152:155], v[56:59], v[128:143]
    ds_read_b64_tr_b16 v[152:153], v161 offset:32768
    ds_read_b64_tr_b16 v[154:155], v161 offset:33280
    ds_read_b128 v[72:75], v160 offset:28672
    v_xor_b32 v160, 32, v160
    s_add_u32 m0, s56, 16384
    s_nop 0
    buffer_load_dwordx4 v164, s[8:11], s54 offen lds
    v_mfma_f32_32x32x16_bf16 v[128:143], v[156:159], v[60:63], v[128:143]
    ds_read_b64_tr_b16 v[156:157], v161 offset:34816
    ds_read_b64_tr_b16 v[158:159], v161 offset:35328
    ds_read_b128 v[76:79], v160 offset:28672
    v_xor_b32 v160, 96, v160
    s_waitcnt lgkmcnt(0)
    s_waitcnt vmcnt(3)
    s_barrier
    v_add_u32 v161, 57344, v161
    v_mfma_f32_32x32x16_bf16 v[128:143], v[144:147], v[64:67], v[128:143]
    ds_read_b64_tr_b16 v[144:145], v161 offset:0
    ds_read_b64_tr_b16 v[146:147], v161 offset:512
    ds_read_b128 v[80:83], v160 offset:57344
    v_xor_b32 v160, 32, v160
    s_add_u32 s53, s51, 7
    s_and_b32 s53, s53, 7
    s_mul_i32 s53, s53, 128
    s_add_u32 m0, s59, 28672
    s_nop 0
    buffer_load_dwordx4 v162, s[4:7], s53 offen lds
    v_mfma_f32_32x32x16_bf16 v[128:143], v[148:151], v[68:71], v[128:143]
    ds_read_b64_tr_b16 v[148:149], v161 offset:2048
    ds_read_b64_tr_b16 v[150:151], v161 offset:2560
    ds_read_b128 v[84:87], v160 offset:57344
    v_xor_b32 v160, 96, v160
    s_add_u32 m0, s59, 29696
    s_mul_i32 s54, s53, 1536
    buffer_load_dwordx4 v163, s[4:7], s53 offen lds
    v_mfma_f32_32x32x16_bf16 v[128:143], v[152:155], v[72:75], v[128:143]
    ds_read_b64_tr_b16 v[152:153], v161 offset:4096
    ds_read_b64_tr_b16 v[154:155], v161 offset:4608
    ds_read_b128 v[88:91], v160 offset:57344
    v_xor_b32 v160, 32, v160
    s_add_u32 m0, s56, 45056
    s_nop 0
    buffer_load_dwordx4 v164, s[8:11], s54 offen lds
    v_mfma_f32_32x32x16_bf16 v[128:143], v[156:159], v[76:79], v[128:143]
    ds_read_b64_tr_b16 v[156:157], v161 offset:6144
    ds_read_b64_tr_b16 v[158:159], v161 offset:6656
    ds_read_b128 v[92:95], v160 offset:57344
    v_xor_b32 v160, 96, v160
    s_waitcnt lgkmcnt(0)
    s_waitcnt vmcnt(3)
    s_barrier
    s_lshl_b32 s53, s48, 6
    v_add_u32 v166, s53, v165
    v_mul_u32_u24 v167, 43691, v166
    s_mul_i32 s53, s49, 192
    v_lshrrev_b32 v167, 19, v167
    s_movk_i32 s54, 2752
    v_mad_i32_i24 v166, v167, -12, v166
    v_lshl_add_u32 v166, v166, 4, s53
    v_min_u32 v166, 2736, v166
    v_mad_u32_u24 v162, v167, s54, v166
    v_add_u32 v161, 4294909952, v161
    v_mfma_f32_32x32x16_bf16 v[128:143], v[144:147], v[80:83], v[128:143]
    ds_read_b64_tr_b16 v[144:145], v161 offset:0
    ds_read_b64_tr_b16 v[146:147], v161 offset:512
    ds_read_b128 v[96:99], v160 offset:0
    v_xor_b32 v160, 32, v160
    s_add_u32 s53, s51, 0
    s_and_b32 s53, s53, 7
    s_mul_i32 s53, s53, 176128
    s_add_u32 m0, s56, 86016
    s_nop 0
    buffer_load_dwordx4 v162, s[12:15], s53 offen lds
    v_mfma_f32_32x32x16_bf16 v[128:143], v[148:151], v[84:87], v[128:143]
    ds_read_b64_tr_b16 v[148:149], v161 offset:2048
    ds_read_b64_tr_b16 v[150:151], v161 offset:2560
    ds_read_b128 v[100:103], v160 offset:0
    v_xor_b32 v160, 96, v160
    s_add_u32 s53, s51, 1
    s_and_b32 s53, s53, 7
    s_mul_i32 s53, s53, 176128
    s_add_u32 m0, s56, 98304
    s_nop 0
    buffer_load_dwordx4 v162, s[12:15], s53 offen lds
    v_mfma_f32_32x32x16_bf16 v[128:143], v[152:155], v[88:91], v[128:143]
    ds_read_b64_tr_b16 v[152:153], v161 offset:4096
    ds_read_b64_tr_b16 v[154:155], v161 offset:4608
    ds_read_b128 v[104:107], v160 offset:0
    v_xor_b32 v160, 32, v160
    v_mfma_f32_32x32x16_bf16 v[128:143], v[156:159], v[92:95], v[128:143]
    ds_read_b64_tr_b16 v[156:157], v161 offset:6144
    ds_read_b64_tr_b16 v[158:159], v161 offset:6656
    ds_read_b128 v[108:111], v160 offset:0
    v_xor_b32 v160, 96, v160
    s_waitcnt lgkmcnt(0)
    s_waitcnt vmcnt(2)
    s_barrier
    v_mfma_f32_32x32x16_bf16 v[128:143], v[144:147], v[96:99], v[128:143]
    ds_read_b64_tr_b16 v[144:145], v161 offset:28672
    ds_read_b64_tr_b16 v[146:147], v161 offset:29184
    ds_read_b128 v[112:115], v160 offset:28672
    v_xor_b32 v160, 32, v160
    s_add_u32 s53, s51, 2
    s_and_b32 s53, s53, 7
    s_mul_i32 s53, s53, 176128
    s_add_u32 m0, s56, 114688
    s_nop 0
    buffer_load_dwordx4 v162, s[12:15], s53 offen lds
    v_mfma_f32_32x32x16_bf16 v[128:143], v[148:151], v[100:103], v[128:143]
    ds_read_b64_tr_b16 v[148:149], v161 offset:30720
    ds_read_b64_tr_b16 v[150:151], v161 offset:31232
    ds_read_b128 v[116:119], v160 offset:28672
    v_xor_b32 v160, 96, v160
    s_add_u32 s53, s51, 3
    s_and_b32 s53, s53, 7
    s_mul_i32 s53, s53, 176128
    s_add_u32 m0, s56, 126976
    s_nop 0
    buffer_load_dwordx4 v162, s[12:15], s53 offen lds
    v_mfma_f32_32x32x16_bf16 v[128:143], v[152:155], v[104:107], v[128:143]
    ds_read_b64_tr_b16 v[152:153], v161 offset:32768
    ds_read_b64_tr_b16 v[154:155], v161 offset:33280
    ds_read_b128 v[120:123], v160 offset:28672
    v_xor_b32 v160, 32, v160
    v_mfma_f32_32x32x16_bf16 v[128:143], v[156:159], v[108:111], v[128:143]
    ds_read_b64_tr_b16 v[156:157], v161 offset:34816
    ds_read_b64_tr_b16 v[158:159], v161 offset:35328
    ds_read_b128 v[124:127], v160 offset:28672
    v_xor_b32 v160, 96, v160
    s_waitcnt lgkmcnt(9)
    v_mfma_f32_32x32x16_bf16 v[128:143], v[144:147], v[112:115], v[128:143]
    s_waitcnt lgkmcnt(6)
    v_mfma_f32_32x32x16_bf16 v[128:143], v[148:151], v[116:119], v[128:143]
    s_waitcnt lgkmcnt(3)
    v_mfma_f32_32x32x16_bf16 v[128:143], v[152:155], v[120:123], v[128:143]
    s_waitcnt lgkmcnt(0)
    v_mfma_f32_32x32x16_bf16 v[128:143], v[156:159], v[124:127], v[128:143]
    v_lshrrev_b32 v166, 5, v165
    v_lshlrev_b32 v166, 3, v166
    s_lshl_b32 s53, s55, 6
    s_add_u32 s53, s53, 162816
    v_add_u32 v166, s53, v166
    ds_read_b64 v[152:153], v166 offset:0
    ds_read_b64 v[154:155], v166 offset:16
    ds_read_b64 v[156:157], v166 offset:32
    ds_read_b64 v[158:159], v166 offset:48
    v_mov_b32 v163, 0
    s_mov_b64 exec, 1
    buffer_load_dword v160, v163, s[40:43], 0 offen sc1
    s_mov_b64 exec, -1
    s_lshl_b32 s53, s58, 1
    s_add_u32 s53, s53, s55
    s_lshl_b32 s53, s53, 18
    s_lshl_b32 s54, s50, 2
    s_add_u32 s54, s54, s52
    s_lshl_b32 s54, s54, 11
    s_add_u32 s53, s53, s54
    s_add_u32 s53, s53, 1048576
    v_and_b32 v164, 0x33, v165
    v_bfe_u32 v163, v165, 2, 1
    v_lshl_add_u32 v164, v163, 3, v164
    v_bfe_u32 v163, v165, 3, 1
    v_lshl_add_u32 v164, v163, 2, v164
    v_lshlrev_b32 v164, 4, v164
    s_add_u32 s54, s53, 131072
    v_cvt_pk_bf16_f32 v144, v128, v129
    v_cvt_pk_bf16_f32 v145, v130, v131
    v_cvt_pk_bf16_f32 v146, v132, v133
    v_cvt_pk_bf16_f32 v147, v134, v135
    v_cvt_pk_bf16_f32 v148, v136, v137
    v_cvt_pk_bf16_f32 v149, v138, v139
    v_cvt_pk_bf16_f32 v150, v140, v141
    v_cvt_pk_bf16_f32 v151, v142, v143
    buffer_store_dwordx4 v[144:147], v164, s[44:47], s53 offen sc1
    buffer_store_dwordx4 v[148:151], v164, s[44:47], s54 offen sc1
    s_branch L_kvffn
L_roleV:
    s_waitcnt vmcnt(3)
    s_barrier
    ds_read_b64_tr_b16 v[144:145], v161 offset:0
    ds_read_b64_tr_b16 v[146:147], v161 offset:512
    ds_read_b128 v[0:3], v160 offset:0
    v_xor_b32 v160, 32, v160
    s_add_u32 s53, s51, 2
    s_and_b32 s53, s53, 7
    s_mul_i32 s53, s53, 128
    s_add_u32 m0, s59, 57344
    s_nop 0
    buffer_load_dwordx4 v162, s[4:7], s53 offen lds
    ds_read_b64_tr_b16 v[148:149], v161 offset:2048
    ds_read_b64_tr_b16 v[150:151], v161 offset:2560
    ds_read_b128 v[4:7], v160 offset:0
    v_xor_b32 v160, 96, v160
    s_add_u32 m0, s59, 58368
    s_mul_i32 s54, s53, 1536
    buffer_load_dwordx4 v163, s[4:7], s53 offen lds
    ds_read_b64_tr_b16 v[152:153], v161 offset:4096
    ds_read_b64_tr_b16 v[154:155], v161 offset:4608
    ds_read_b128 v[8:11], v160 offset:0
    v_xor_b32 v160, 32, v160
    s_add_u32 m0, s56, 73728
    s_nop 0
    buffer_load_dwordx4 v164, s[8:11], s54 offen lds
    ds_read_b64_tr_b16 v[156:157], v161 offset:6144
    ds_read_b64_tr_b16 v[158:159], v161 offset:6656
    ds_read_b128 v[12:15], v160 offset:0
    v_xor_b32 v160, 96, v160
    s_waitcnt lgkmcnt(0)
    s_waitcnt vmcnt(3)
    s_barrier
    v_mfma_f32_32x32x16_bf16 v[128:143], v[0:3], v[144:147], 0
    ds_read_b64_tr_b16 v[144:145], v161 offset:28672
    ds_read_b64_tr_b16 v[146:147], v161 offset:29184
    ds_read_b128 v[16:19], v160 offset:28672
    v_xor_b32 v160, 32, v160
    s_add_u32 s53, s51, 3
    s_and_b32 s53, s53, 7
    s_mul_i32 s53, s53, 128
    s_add_u32 m0, s59, 0
    s_nop 0
    buffer_load_dwordx4 v162, s[4:7], s53 offen lds
    v_mfma_f32_32x32x16_bf16 v[128:143], v[4:7], v[148:151], v[128:143]
    ds_read_b64_tr_b16 v[148:149], v161 offset:30720
    ds_read_b64_tr_b16 v[150:151], v161 offset:31232
    ds_read_b128 v[20:23], v160 offset:28672
    v_xor_b32 v160, 96, v160
    s_add_u32 m0, s59, 1024
    s_mul_i32 s54, s53, 1536
    buffer_load_dwordx4 v163, s[4:7], s53 offen lds
    v_mfma_f32_32x32x16_bf16 v[128:143], v[8:11], v[152:155], v[128:143]
    ds_read_b64_tr_b16 v[152:153], v161 offset:32768
    ds_read_b64_tr_b16 v[154:155], v161 offset:33280
    ds_read_b128 v[24:27], v160 offset:28672
    v_xor_b32 v160, 32, v160
    s_add_u32 m0, s56, 16384
    s_nop 0
    buffer_load_dwordx4 v164, s[8:11], s54 offen lds
    v_mfma_f32_32x32x16_bf16 v[128:143], v[12:15], v[156:159], v[128:143]
    ds_read_b64_tr_b16 v[156:157], v161 offset:34816
    ds_read_b64_tr_b16 v[158:159], v161 offset:35328
    ds_read_b128 v[28:31], v160 offset:28672
    v_xor_b32 v160, 96, v160
    s_waitcnt lgkmcnt(0)
    s_waitcnt vmcnt(3)
    s_barrier
    v_add_u32 v161, 57344, v161
    v_mfma_f32_32x32x16_bf16 v[128:143], v[16:19], v[144:147], v[128:143]
    ds_read_b64_tr_b16 v[144:145], v161 offset:0
    ds_read_b64_tr_b16 v[146:147], v161 offset:512
    ds_read_b128 v[32:35], v160 offset:57344
    v_xor_b32 v160, 32, v160
    s_add_u32 s53, s51, 4
    s_and_b32 s53, s53, 7
    s_mul_i32 s53, s53, 128
    s_add_u32 m0, s59, 28672
    s_nop 0
    buffer_load_dwordx4 v162, s[4:7], s53 offen lds
    v_mfma_f32_32x32x16_bf16 v[128:143], v[20:23], v[148:151], v[128:143]
    ds_read_b64_tr_b16 v[148:149], v161 offset:2048
    ds_read_b64_tr_b16 v[150:151], v161 offset:2560
    ds_read_b128 v[36:39], v160 offset:57344
    v_xor_b32 v160, 96, v160
    s_add_u32 m0, s59, 29696
    s_mul_i32 s54, s53, 1536
    buffer_load_dwordx4 v163, s[4:7], s53 offen lds
    v_mfma_f32_32x32x16_bf16 v[128:143], v[24:27], v[152:155], v[128:143]
    ds_read_b64_tr_b16 v[152:153], v161 offset:4096
    ds_read_b64_tr_b16 v[154:155], v161 offset:4608
    ds_read_b128 v[40:43], v160 offset:57344
    v_xor_b32 v160, 32, v160
    s_add_u32 m0, s56, 45056
    s_nop 0
    buffer_load_dwordx4 v164, s[8:11], s54 offen lds
    v_mfma_f32_32x32x16_bf16 v[128:143], v[28:31], v[156:159], v[128:143]
    ds_read_b64_tr_b16 v[156:157], v161 offset:6144
    ds_read_b64_tr_b16 v[158:159], v161 offset:6656
    ds_read_b128 v[44:47], v160 offset:57344
    v_xor_b32 v160, 96, v160
    s_waitcnt lgkmcnt(0)
    s_waitcnt vmcnt(3)
    s_barrier
    v_add_u32 v161, 4294909952, v161
    v_mfma_f32_32x32x16_bf16 v[128:143], v[32:35], v[144:147], v[128:143]
    ds_read_b64_tr_b16 v[144:145], v161 offset:0
    ds_read_b64_tr_b16 v[146:147], v161 offset:512
    ds_read_b128 v[48:51], v160 offset:0
    v_xor_b32 v160, 32, v160
    s_add_u32 s53, s51, 5
    s_and_b32 s53, s53, 7
    s_mul_i32 s53, s53, 128
    s_add_u32 m0, s59, 57344
    s_nop 0
    buffer_load_dwordx4 v162, s[4:7], s53 offen lds
    v_mfma_f32_32x32x16_bf16 v[128:143], v[36:39], v[148:151], v[128:143]
    ds_read_b64_tr_b16 v[148:149], v161 offset:2048
    ds_read_b64_tr_b16 v[150:151], v161 offset:2560
    ds_read_b128 v[52:55], v160 offset:0
    v_xor_b32 v160, 96, v160
    s_add_u32 m0, s59, 58368
    s_mul_i32 s54, s53, 1536
    buffer_load_dwordx4 v163, s[4:7], s53 offen lds
    v_mfma_f32_32x32x16_bf16 v[128:143], v[40:43], v[152:155], v[128:143]
    ds_read_b64_tr_b16 v[152:153], v161 offset:4096
    ds_read_b64_tr_b16 v[154:155], v161 offset:4608
    ds_read_b128 v[56:59], v160 offset:0
    v_xor_b32 v160, 32, v160
    s_add_u32 m0, s56, 73728
    s_nop 0
    buffer_load_dwordx4 v164, s[8:11], s54 offen lds
    v_mfma_f32_32x32x16_bf16 v[128:143], v[44:47], v[156:159], v[128:143]
    ds_read_b64_tr_b16 v[156:157], v161 offset:6144
    ds_read_b64_tr_b16 v[158:159], v161 offset:6656
    ds_read_b128 v[60:63], v160 offset:0
    v_xor_b32 v160, 96, v160
    s_waitcnt lgkmcnt(0)
    s_waitcnt vmcnt(3)
    s_barrier
    v_mfma_f32_32x32x16_bf16 v[128:143], v[48:51], v[144:147], v[128:143]
    ds_read_b64_tr_b16 v[144:145], v161 offset:28672
    ds_read_b64_tr_b16 v[146:147], v161 offset:29184
    ds_read_b128 v[64:67], v160 offset:28672
    v_xor_b32 v160, 32, v160
    s_add_u32 s53, s51, 6
    s_and_b32 s53, s53, 7
    s_mul_i32 s53, s53, 128
    s_add_u32 m0, s59, 0
    s_nop 0
    buffer_load_dwordx4 v162, s[4:7], s53 offen lds
    v_mfma_f32_32x32x16_bf16 v[128:143], v[52:55], v[148:151], v[128:143]
    ds_read_b64_tr_b16 v[148:149], v161 offset:30720
    ds_read_b64_tr_b16 v[150:151], v161 offset:31232
    ds_read_b128 v[68:71], v160 offset:28672
    v_xor_b32 v160, 96, v160
    s_add_u32 m0, s59, 1024
    s_mul_i32 s54, s53, 1536
    buffer_load_dwordx4 v163, s[4:7], s53 offen lds
    v_mfma_f32_32x32x16_bf16 v[128:143], v[56:59], v[152:155], v[128:143]
    ds_read_b64_tr_b16 v[152:153], v161 offset:32768
    ds_read_b64_tr_b16 v[154:155], v161 offset:33280
    ds_read_b128 v[72:75], v160 offset:28672
    v_xor_b32 v160, 32, v160
    s_add_u32 m0, s56, 16384
    s_nop 0
    buffer_load_dwordx4 v164, s[8:11], s54 offen lds
    v_mfma_f32_32x32x16_bf16 v[128:143], v[60:63], v[156:159], v[128:143]
    ds_read_b64_tr_b16 v[156:157], v161 offset:34816
    ds_read_b64_tr_b16 v[158:159], v161 offset:35328
    ds_read_b128 v[76:79], v160 offset:28672
    v_xor_b32 v160, 96, v160
    s_waitcnt lgkmcnt(0)
    s_waitcnt vmcnt(3)
    s_barrier
    v_add_u32 v161, 57344, v161
    v_mfma_f32_32x32x16_bf16 v[128:143], v[64:67], v[144:147], v[128:143]
    ds_read_b64_tr_b16 v[144:145], v161 offset:0
    ds_read_b64_tr_b16 v[146:147], v161 offset:512
    ds_read_b128 v[80:83], v160 offset:57344
    v_xor_b32 v160, 32, v160
    s_add_u32 s53, s51, 7
    s_and_b32 s53, s53, 7
    s_mul_i32 s53, s53, 128
    s_add_u32 m0, s59, 28672
    s_nop 0
    buffer_load_dwordx4 v162, s[4:7], s53 offen lds
    v_mfma_f32_32x32x16_bf16 v[128:143], v[68:71], v[148:151], v[128:143]
    ds_read_b64_tr_b16 v[148:149], v161 offset:2048
    ds_read_b64_tr_b16 v[150:151], v161 offset:2560
    ds_read_b128 v[84:87], v160 offset:57344
    v_xor_b32 v160, 96, v160
    s_add_u32 m0, s59, 29696
    s_mul_i32 s54, s53, 1536
    buffer_load_dwordx4 v163, s[4:7], s53 offen lds
    v_mfma_f32_32x32x16_bf16 v[128:143], v[72:75], v[152:155], v[128:143]
    ds_read_b64_tr_b16 v[152:153], v161 offset:4096
    ds_read_b64_tr_b16 v[154:155], v161 offset:4608
    ds_read_b128 v[88:91], v160 offset:57344
    v_xor_b32 v160, 32, v160
    s_add_u32 m0, s56, 45056
    s_nop 0
    buffer_load_dwordx4 v164, s[8:11], s54 offen lds
    v_mfma_f32_32x32x16_bf16 v[128:143], v[76:79], v[156:159], v[128:143]
    ds_read_b64_tr_b16 v[156:157], v161 offset:6144
    ds_read_b64_tr_b16 v[158:159], v161 offset:6656
    ds_read_b128 v[92:95], v160 offset:57344
    v_xor_b32 v160, 96, v160
    s_waitcnt lgkmcnt(0)
    s_waitcnt vmcnt(3)
    s_barrier
    s_lshl_b32 s53, s48, 6
    v_add_u32 v166, s53, v165
    v_mul_u32_u24 v167, 43691, v166
    s_mul_i32 s53, s49, 192
    v_lshrrev_b32 v167, 19, v167
    s_movk_i32 s54, 2752
    v_mad_i32_i24 v166, v167, -12, v166
    v_lshl_add_u32 v166, v166, 4, s53
    v_min_u32 v166, 2736, v166
    v_mad_u32_u24 v162, v167, s54, v166
    v_add_u32 v161, 4294909952, v161
    v_mfma_f32_32x32x16_bf16 v[128:143], v[80:83], v[144:147], v[128:143]
    ds_read_b64_tr_b16 v[144:145], v161 offset:0
    ds_read_b64_tr_b16 v[146:147], v161 offset:512
    ds_read_b128 v[96:99], v160 offset:0
    v_xor_b32 v160, 32, v160
    s_add_u32 s53, s51, 0
    s_and_b32 s53, s53, 7
    s_mul_i32 s53, s53, 176128
    s_add_u32 m0, s56, 86016
    s_nop 0
    buffer_load_dwordx4 v162, s[12:15], s53 offen lds
    v_mfma_f32_32x32x16_bf16 v[128:143], v[84:87], v[148:151], v[128:143]
    ds_read_b64_tr_b16 v[148:149], v161 offset:2048
    ds_read_b64_tr_b16 v[150:151], v161 offset:2560
    ds_read_b128 v[100:103], v160 offset:0
    v_xor_b32 v160, 96, v160
    s_add_u32 s53, s51, 1
    s_and_b32 s53, s53, 7
    s_mul_i32 s53, s53, 176128
    s_add_u32 m0, s56, 98304
    s_nop 0
    buffer_load_dwordx4 v162, s[12:15], s53 offen lds
    v_mfma_f32_32x32x16_bf16 v[128:143], v[88:91], v[152:155], v[128:143]
    ds_read_b64_tr_b16 v[152:153], v161 offset:4096
    ds_read_b64_tr_b16 v[154:155], v161 offset:4608
    ds_read_b128 v[104:107], v160 offset:0
    v_xor_b32 v160, 32, v160
    v_mfma_f32_32x32x16_bf16 v[128:143], v[92:95], v[156:159], v[128:143]
    ds_read_b64_tr_b16 v[156:157], v161 offset:6144
    ds_read_b64_tr_b16 v[158:159], v161 offset:6656
    ds_read_b128 v[108:111], v160 offset:0
    v_xor_b32 v160, 96, v160
    s_waitcnt lgkmcnt(0)
    s_waitcnt vmcnt(2)
    s_barrier
    v_mfma_f32_32x32x16_bf16 v[128:143], v[96:99], v[144:147], v[128:143]
    ds_read_b64_tr_b16 v[144:145], v161 offset:28672
    ds_read_b64_tr_b16 v[146:147], v161 offset:29184
    ds_read_b128 v[112:115], v160 offset:28672
    v_xor_b32 v160, 32, v160
    s_add_u32 s53, s51, 2
    s_and_b32 s53, s53, 7
    s_mul_i32 s53, s53, 176128
    s_add_u32 m0, s56, 114688
    s_nop 0
    buffer_load_dwordx4 v162, s[12:15], s53 offen lds
    v_mfma_f32_32x32x16_bf16 v[128:143], v[100:103], v[148:151], v[128:143]
    ds_read_b64_tr_b16 v[148:149], v161 offset:30720
    ds_read_b64_tr_b16 v[150:151], v161 offset:31232
    ds_read_b128 v[116:119], v160 offset:28672
    v_xor_b32 v160, 96, v160
    s_add_u32 s53, s51, 3
    s_and_b32 s53, s53, 7
    s_mul_i32 s53, s53, 176128
    s_add_u32 m0, s56, 126976
    s_nop 0
    buffer_load_dwordx4 v162, s[12:15], s53 offen lds
    v_mfma_f32_32x32x16_bf16 v[128:143], v[104:107], v[152:155], v[128:143]
    ds_read_b64_tr_b16 v[152:153], v161 offset:32768
    ds_read_b64_tr_b16 v[154:155], v161 offset:33280
    ds_read_b128 v[120:123], v160 offset:28672
    v_xor_b32 v160, 32, v160
    v_mfma_f32_32x32x16_bf16 v[128:143], v[108:111], v[156:159], v[128:143]
    ds_read_b64_tr_b16 v[156:157], v161 offset:34816
    ds_read_b64_tr_b16 v[158:159], v161 offset:35328
    ds_read_b128 v[124:127], v160 offset:28672
    v_xor_b32 v160, 96, v160
    s_waitcnt lgkmcnt(9)
    v_mfma_f32_32x32x16_bf16 v[128:143], v[112:115], v[144:147], v[128:143]
    s_waitcnt lgkmcnt(6)
    v_mfma_f32_32x32x16_bf16 v[128:143], v[116:119], v[148:151], v[128:143]
    s_waitcnt lgkmcnt(3)
    v_mfma_f32_32x32x16_bf16 v[128:143], v[120:123], v[152:155], v[128:143]
    s_waitcnt lgkmcnt(0)
    v_mfma_f32_32x32x16_bf16 v[128:143], v[124:127], v[156:159], v[128:143]
    v_lshrrev_b32 v166, 5, v165
    v_lshlrev_b32 v166, 3, v166
    s_lshl_b32 s53, s55, 6
    s_add_u32 s53, s53, 162816
    v_add_u32 v166, s53, v166
    ds_read_b64 v[152:153], v166 offset:0
    ds_read_b64 v[154:155], v166 offset:16
    ds_read_b64 v[156:157], v166 offset:32
    ds_read_b64 v[158:159], v166 offset:48
    v_mov_b32 v163, 0
    s_mov_b64 exec, 1
    buffer_load_dword v160, v163, s[40:43], 0 offen sc1
    s_mov_b64 exec, -1
    s_lshl_b32 s53, s58, 1
    s_add_u32 s53, s53, s55
    s_lshl_b32 s53, s53, 18
    s_lshl_b32 s54, s50, 2
    s_add_u32 s54, s54, s52
    s_lshl_b32 s54, s54, 11
    s_add_u32 s53, s53, s54
    s_add_u32 s53, s53, 1048576
    v_and_b32 v164, 15, v165
    v_lshlrev_b32 v164, 4, v164
    v_lshrrev_b32 v163, 5, v165
    v_lshl_add_u32 v164, v163, 8, v164
    v_bfe_u32 v163, v165, 4, 1
    v_lshl_add_u32 v164, v163, 17, v164
    s_nop 0
    v_cvt_pk_bf16_f32 v144, v128, v129
    v_cvt_pk_bf16_f32 v145, v130, v131
    v_cvt_pk_bf16_f32 v146, v132, v133
    v_cvt_pk_bf16_f32 v147, v134, v135
    v_cvt_pk_bf16_f32 v148, v136, v137
    v_cvt_pk_bf16_f32 v149, v138, v139
    v_cvt_pk_bf16_f32 v150, v140, v141
    v_cvt_pk_bf16_f32 v151, v142, v143
    buffer_store_dwordx4 v[144:147], v164, s[44:47], s53 offen offset:1024 sc1
    buffer_store_dwordx4 v[148:151], v164, s[44:47], s53 offen offset:1536 sc1
L_kvffn:
    s_lshl_b32 s53, s55, 6
    v_lshrrev_b32 v166, 5, v165
    v_bfe_u32 v167, v165, 2, 2
    v_lshl_add_u32 v166, v166, 3, v167
    v_mul_u32_u24 v166, 192, v166
    v_add_u32 v166, s53, v166
    v_bfe_u32 v167, v165, 4, 1
    v_lshl_add_u32 v166, v167, 5, v166
    v_and_b32 v167, 3, v165
    v_lshl_add_u32 v161, v167, 3, v166
    s_waitcnt lgkmcnt(0)
    v_lshlrev_b32 v128, 16, v152
    v_and_b32 v129, 0xffff0000, v152
    v_lshlrev_b32 v130, 16, v153
    v_and_b32 v131, 0xffff0000, v153
    v_lshlrev_b32 v132, 16, v154
    v_and_b32 v133, 0xffff0000, v154
    v_lshlrev_b32 v134, 16, v155
    v_and_b32 v135, 0xffff0000, v155
    v_lshlrev_b32 v136, 16, v156
    v_and_b32 v137, 0xffff0000, v156
    v_lshlrev_b32 v138, 16, v157
    v_and_b32 v139, 0xffff0000, v157
    v_lshlrev_b32 v140, 16, v158
    v_and_b32 v141, 0xffff0000, v158
    v_lshlrev_b32 v142, 16, v159
    v_and_b32 v143, 0xffff0000, v159
    s_waitcnt vmcnt(5)
    s_barrier
    s_waitcnt vmcnt(0)
    v_mov_b32 v166, 163648
    v_mov_b32 v167, 1
    s_mov_b64 exec, 1
    ds_add_rtn_u32 v166, v166, v167
    s_waitcnt lgkmcnt(0)
    v_cmp_eq_u32 vcc, 7, v166
    s_nop 0
    s_cbranch_vccz L_s1done
L_boot:
    v_cmp_eq_u32 vcc, 1, v160
    s_nop 0
    s_cbranch_vccnz L_bootok
    v_mov_b32 v166, 0
    buffer_load_dword v160, v166, s[40:43], 0 offen sc1
    s_waitcnt vmcnt(0)
    s_sleep 1
    s_branch L_boot
L_bootok:
    s_lshl_b32 s53, s58, 8
    v_mov_b32 v166, 0
    buffer_atomic_add v167, v166, s[44:47], s53 offen sc1
    s_mov_b32 s57, 2
L_s1done:
    s_mov_b64 exec, -1
    v_add_u32 v161, 86016, v161
    ds_read_b64_tr_b16 v[144:145], v161 offset:0
    ds_read_b64_tr_b16 v[146:147], v161 offset:768
    ds_read_b64_tr_b16 v[148:149], v161 offset:3072
    ds_read_b64_tr_b16 v[150:151], v161 offset:3840
    ds_read_b64_tr_b16 v[152:153], v161 offset:6144
    ds_read_b64_tr_b16 v[154:155], v161 offset:6912
    ds_read_b64_tr_b16 v[156:157], v161 offset:9216
    ds_read_b64_tr_b16 v[158:159], v161 offset:9984
    s_waitcnt lgkmcnt(6)
    v_mfma_f32_32x32x16_bf16 v[128:143], v[144:147], v[0:3], v[128:143]
    ds_read_b64_tr_b16 v[144:145], v161 offset:12288
    ds_read_b64_tr_b16 v[146:147], v161 offset:13056
    s_add_u32 s53, s51, 4
    s_and_b32 s53, s53, 7
    s_mul_i32 s53, s53, 176128
    s_add_u32 m0, s56, 57344
    s_nop 0
    buffer_load_dwordx4 v162, s[12:15], s53 offen lds
    s_waitcnt lgkmcnt(6)
    v_mfma_f32_32x32x16_bf16 v[128:143], v[148:151], v[4:7], v[128:143]
    ds_read_b64_tr_b16 v[148:149], v161 offset:15360
    ds_read_b64_tr_b16 v[150:151], v161 offset:16128
    s_add_u32 s53, s51, 5
    s_and_b32 s53, s53, 7
    s_mul_i32 s53, s53, 176128
    s_add_u32 m0, s56, 69632
    s_nop 0
    buffer_load_dwordx4 v162, s[12:15], s53 offen lds
    s_waitcnt lgkmcnt(6)
    v_mfma_f32_32x32x16_bf16 v[128:143], v[152:155], v[8:11], v[128:143]
    ds_read_b64_tr_b16 v[152:153], v161 offset:18432
    ds_read_b64_tr_b16 v[154:155], v161 offset:19200
    s_add_u32 s53, s51, 6
    s_and_b32 s53, s53, 7
    s_mul_i32 s53, s53, 176128
    s_add_u32 m0, s56, 0
    s_nop 0
    buffer_load_dwordx4 v162, s[12:15], s53 offen lds
    s_waitcnt lgkmcnt(6)
    v_mfma_f32_32x32x16_bf16 v[128:143], v[156:159], v[12:15], v[128:143]
    ds_read_b64_tr_b16 v[156:157], v161 offset:21504
    ds_read_b64_tr_b16 v[158:159], v161 offset:22272
    s_add_u32 s53, s51, 7
    s_and_b32 s53, s53, 7
    s_mul_i32 s53, s53, 176128
    s_add_u32 m0, s56, 12288
    s_nop 0
    buffer_load_dwordx4 v162, s[12:15], s53 offen lds
    s_waitcnt lgkmcnt(6)
    v_mfma_f32_32x32x16_bf16 v[128:143], v[144:147], v[16:19], v[128:143]
    s_waitcnt lgkmcnt(4)
    v_mfma_f32_32x32x16_bf16 v[128:143], v[148:151], v[20:23], v[128:143]
    s_waitcnt lgkmcnt(2)
    v_mfma_f32_32x32x16_bf16 v[128:143], v[152:155], v[24:27], v[128:143]
    s_waitcnt lgkmcnt(0)
    v_mfma_f32_32x32x16_bf16 v[128:143], v[156:159], v[28:31], v[128:143]
    s_waitcnt vmcnt(7)
    s_barrier
    ds_read_b64_tr_b16 v[144:145], v161 offset:28672
    ds_read_b64_tr_b16 v[146:147], v161 offset:29440
    ds_read_b64_tr_b16 v[148:149], v161 offset:31744
    ds_read_b64_tr_b16 v[150:151], v161 offset:32512
    ds_read_b64_tr_b16 v[152:153], v161 offset:34816
    ds_read_b64_tr_b16 v[154:155], v161 offset:35584
    ds_read_b64_tr_b16 v[156:157], v161 offset:37888
    ds_read_b64_tr_b16 v[158:159], v161 offset:38656
    s_waitcnt lgkmcnt(6)
    v_mfma_f32_32x32x16_bf16 v[128:143], v[144:147], v[32:35], v[128:143]
    ds_read_b64_tr_b16 v[144:145], v161 offset:40960
    ds_read_b64_tr_b16 v[146:147], v161 offset:41728
    v_mov_b32 v4, 1065369472
    v_mov_b32 v5, 1065369472
    v_mov_b32 v6, 1065369472
    v_mov_b32 v7, 1065369472
    s_waitcnt lgkmcnt(6)
    v_mfma_f32_32x32x16_bf16 v[128:143], v[148:151], v[36:39], v[128:143]
    ds_read_b64_tr_b16 v[148:149], v161 offset:44032
    ds_read_b64_tr_b16 v[150:151], v161 offset:44800
    v_mov_b32 v8, 1065369472
    v_mov_b32 v9, 1065369472
    s_waitcnt lgkmcnt(6)
    v_mfma_f32_32x32x16_bf16 v[128:143], v[152:155], v[40:43], v[128:143]
    ds_read_b64_tr_b16 v[152:153], v161 offset:47104
    ds_read_b64_tr_b16 v[154:155], v161 offset:47872
    v_mov_b32 v10, 1065369472
    v_mov_b32 v11, 1065369472
    s_waitcnt lgkmcnt(6)
    v_mfma_f32_32x32x16_bf16 v[128:143], v[156:159], v[44:47], v[128:143]
    ds_read_b64_tr_b16 v[156:157], v161 offset:50176
    ds_read_b64_tr_b16 v[158:159], v161 offset:50944
    v_mov_b32 v16, 1065369472
    v_mov_b32 v17, 1065369472
    s_waitcnt lgkmcnt(6)
    v_mfma_f32_32x32x16_bf16 v[128:143], v[144:147], v[48:51], v[128:143]
    v_mov_b32 v18, 1065369472
    v_mov_b32 v19, 1065369472
    v_mov_b32 v20, 1065369472
    v_mov_b32 v21, 1065369472
    s_waitcnt lgkmcnt(4)
    v_mfma_f32_32x32x16_bf16 v[128:143], v[148:151], v[52:55], v[128:143]
    v_mov_b32 v22, 1065369472
    v_mov_b32 v23, 1065369472
    s_waitcnt lgkmcnt(2)
    v_mfma_f32_32x32x16_bf16 v[128:143], v[152:155], v[56:59], v[128:143]
    v_mov_b32 v28, 1065369472
    v_mov_b32 v29, 1065369472
    s_waitcnt lgkmcnt(0)
    v_mfma_f32_32x32x16_bf16 v[128:143], v[156:159], v[60:63], v[128:143]
    v_mov_b32 v30, 1065369472
    v_mov_b32 v31, 1065369472
    s_waitcnt vmcnt(0)
    s_barrier
    v_add_u32 v161, 4294938624, v161
    ds_read_b64_tr_b16 v[144:145], v161 offset:0
    ds_read_b64_tr_b16 v[146:147], v161 offset:768
    ds_read_b64_tr_b16 v[148:149], v161 offset:3072
    ds_read_b64_tr_b16 v[150:151], v161 offset:3840
    ds_read_b64_tr_b16 v[152:153], v161 offset:6144
    ds_read_b64_tr_b16 v[154:155], v161 offset:6912
    ds_read_b64_tr_b16 v[156:157], v161 offset:9216
    ds_read_b64_tr_b16 v[158:159], v161 offset:9984
    s_waitcnt lgkmcnt(6)
    v_mfma_f32_32x32x16_bf16 v[128:143], v[144:147], v[64:67], v[128:143]
    ds_read_b64_tr_b16 v[144:145], v161 offset:12288
    ds_read_b64_tr_b16 v[146:147], v161 offset:13056
    v_mov_b32 v32, 1065369472
    v_mov_b32 v33, 1065369472
    v_mov_b32 v34, 1065369472
    v_mov_b32 v35, 1065369472
    v_mov_b32 v40, 1065369472
    v_mov_b32 v41, 1065369472
    s_waitcnt lgkmcnt(6)
    v_mfma_f32_32x32x16_bf16 v[128:143], v[148:151], v[68:71], v[128:143]
    ds_read_b64_tr_b16 v[148:149], v161 offset:15360
    ds_read_b64_tr_b16 v[150:151], v161 offset:16128
    v_mov_b32 v42, 1065369472
    v_mov_b32 v43, 1065369472
    v_mov_b32 v44, 1065369472
    v_mov_b32 v45, 1065369472
    s_waitcnt lgkmcnt(6)
    v_mfma_f32_32x32x16_bf16 v[128:143], v[152:155], v[72:75], v[128:143]
    ds_read_b64_tr_b16 v[152:153], v161 offset:18432
    ds_read_b64_tr_b16 v[154:155], v161 offset:19200
    v_mov_b32 v46, 1065369472
    v_mov_b32 v47, 1065369472
    s_lshl_b32 s53, s49, 1
    s_add_u32 s53, s53, s55
    s_waitcnt lgkmcnt(6)
    v_mfma_f32_32x32x16_bf16 v[128:143], v[156:159], v[76:79], v[128:143]
    ds_read_b64_tr_b16 v[156:157], v161 offset:21504
    ds_read_b64_tr_b16 v[158:159], v161 offset:22272
    s_lshl_b32 s53, s53, 17
    s_lshl_b32 s54, s52, 11
    s_waitcnt lgkmcnt(6)
    v_mfma_f32_32x32x16_bf16 v[128:143], v[144:147], v[80:83], v[128:143]
    s_add_u32 s53, s53, s54
    s_add_u32 s53, s53, 1048576
    s_waitcnt lgkmcnt(4)
    v_mfma_f32_32x32x16_bf16 v[128:143], v[148:151], v[84:87], v[128:143]
    v_lshl_add_u32 v160, v165, 4, s53
    v_and_b32 v162, 15, v165
    v_lshl_add_u32 v162, v162, 4, s53
    s_waitcnt lgkmcnt(2)
    v_mfma_f32_32x32x16_bf16 v[128:143], v[152:155], v[88:91], v[128:143]
    v_lshrrev_b32 v166, 5, v165
    v_lshl_add_u32 v162, v166, 8, v162
    s_waitcnt lgkmcnt(0)
    v_mfma_f32_32x32x16_bf16 v[128:143], v[156:159], v[92:95], v[128:143]
    v_mov_b32 v163, 0xdddd
    s_lshl_b32 s56, s50, 13
    v_add_u32 v161, 4294909952, v161
    ds_read_b64_tr_b16 v[144:145], v161 offset:0
    ds_read_b64_tr_b16 v[146:147], v161 offset:768
    ds_read_b64_tr_b16 v[148:149], v161 offset:3072
    ds_read_b64_tr_b16 v[150:151], v161 offset:3840
    ds_read_b64_tr_b16 v[152:153], v161 offset:6144
    ds_read_b64_tr_b16 v[154:155], v161 offset:6912
    ds_read_b64_tr_b16 v[156:157], v161 offset:9216
    ds_read_b64_tr_b16 v[158:159], v161 offset:9984
    s_waitcnt lgkmcnt(6)
    v_mfma_f32_32x32x16_bf16 v[128:143], v[144:147], v[96:99], v[128:143]
    ds_read_b64_tr_b16 v[144:145], v161 offset:12288
    ds_read_b64_tr_b16 v[146:147], v161 offset:13056
    v_mov_b64 v[64:65], 0
    v_mov_b64 v[66:67], 0
    s_waitcnt lgkmcnt(6)
    v_mfma_f32_32x32x16_bf16 v[128:143], v[148:151], v[100:103], v[128:143]
    ds_read_b64_tr_b16 v[148:149], v161 offset:15360
    ds_read_b64_tr_b16 v[150:151], v161 offset:16128
    v_mov_b64 v[68:69], 0
    v_mov_b64 v[70:71], 0
    v_mov_b64 v[96:97], 0
    v_mov_b64 v[98:99], 0
    s_waitcnt lgkmcnt(6)
    v_mfma_f32_32x32x16_bf16 v[128:143], v[152:155], v[104:107], v[128:143]
    ds_read_b64_tr_b16 v[152:153], v161 offset:18432
    ds_read_b64_tr_b16 v[154:155], v161 offset:19200
    v_mov_b64 v[72:73], 0
    v_mov_b64 v[74:75], 0
    v_mov_b64 v[100:101], 0
    v_mov_b64 v[102:103], 0
    s_waitcnt lgkmcnt(6)
    v_mfma_f32_32x32x16_bf16 v[128:143], v[156:159], v[108:111], v[128:143]
    ds_read_b64_tr_b16 v[156:157], v161 offset:21504
    ds_read_b64_tr_b16 v[158:159], v161 offset:22272
    v_mov_b64 v[76:77], 0
    v_mov_b64 v[78:79], 0
    v_mov_b64 v[104:105], 0
    v_mov_b64 v[106:107], 0
    s_waitcnt lgkmcnt(6)
    v_mfma_f32_32x32x16_bf16 v[128:143], v[144:147], v[112:115], v[128:143]
    v_mov_b64 v[80:81], 0
    v_mov_b64 v[82:83], 0
    v_mov_b64 v[108:109], 0
    v_mov_b64 v[110:111], 0
    s_waitcnt lgkmcnt(4)
    v_mfma_f32_32x32x16_bf16 v[128:143], v[148:151], v[116:119], v[128:143]
    v_mov_b64 v[84:85], 0
    v_mov_b64 v[86:87], 0
    v_mov_b64 v[112:113], 0
    v_mov_b64 v[114:115], 0
    s_waitcnt lgkmcnt(2)
    v_mfma_f32_32x32x16_bf16 v[128:143], v[152:155], v[120:123], v[128:143]
    v_mov_b64 v[88:89], 0
    v_mov_b64 v[90:91], 0
    v_mov_b64 v[116:117], 0
    v_mov_b64 v[118:119], 0
    s_waitcnt lgkmcnt(0)
    v_mfma_f32_32x32x16_bf16 v[128:143], v[156:159], v[124:127], v[128:143]
    v_mov_b64 v[92:93], 0
    v_mov_b64 v[94:95], 0
    v_mov_b64 v[120:121], 0
    v_mov_b64 v[122:123], 0
    s_add_u32 s53, s52, 0
    s_and_b32 s53, s53, 3
    s_lshl_b32 s54, s55, 2
    s_add_u32 s53, s53, s54
    s_lshl_b32 s53, s53, 10
    s_add_u32 s53, s53, 153600
    v_lshl_add_u32 v166, v165, 4, s53
    ds_read_b128 v[48:51], v166
    s_add_u32 s53, s52, 1
    s_and_b32 s53, s53, 3
    s_lshl_b32 s54, s55, 2
    s_add_u32 s53, s53, s54
    s_lshl_b32 s53, s53, 10
    s_add_u32 s53, s53, 153600
    v_lshl_add_u32 v166, v165, 4, s53
    ds_read_b128 v[52:55], v166
    s_add_u32 s53, s52, 2
    s_and_b32 s53, s53, 3
    s_lshl_b32 s54, s55, 2
    s_add_u32 s53, s53, s54
    s_lshl_b32 s53, s53, 10
    s_add_u32 s53, s53, 153600
    v_lshl_add_u32 v166, v165, 4, s53
    ds_read_b128 v[56:59], v166
    s_add_u32 s53, s52, 3
    s_and_b32 s53, s53, 3
    s_lshl_b32 s54, s55, 2
    s_add_u32 s53, s53, s54
    s_lshl_b32 s53, s53, 10
    s_add_u32 s53, s53, 153600
    v_lshl_add_u32 v166, v165, 4, s53
    ds_read_b128 v[60:63], v166
    s_lshl_b32 s53, s48, 2
    s_add_u32 s53, s53, 163584
    v_mov_b32 v164, s53
    v_mov_b32 v167, 1
    s_mov_b32 s62, 4
    s_nop 6
    v_max_f32 v128, 0, v128
    v_max_f32 v129, 0, v129
    v_max_f32 v130, 0, v130
    v_max_f32 v131, 0, v131
    v_max_f32 v132, 0, v132
    v_max_f32 v133, 0, v133
    v_max_f32 v134, 0, v134
    v_max_f32 v135, 0, v135
    v_max_f32 v136, 0, v136
    v_max_f32 v137, 0, v137
    v_max_f32 v138, 0, v138
    v_max_f32 v139, 0, v139
    v_max_f32 v140, 0, v140
    v_max_f32 v141, 0, v141
    v_max_f32 v142, 0, v142
    v_max_f32 v143, 0, v143
    v_pk_mul_f32 v[128:129], v[128:129], v[128:129]
    v_pk_mul_f32 v[130:131], v[130:131], v[130:131]
    v_pk_mul_f32 v[132:133], v[132:133], v[132:133]
    v_pk_mul_f32 v[134:135], v[134:135], v[134:135]
    v_pk_mul_f32 v[136:137], v[136:137], v[136:137]
    v_pk_mul_f32 v[138:139], v[138:139], v[138:139]
    v_pk_mul_f32 v[140:141], v[140:141], v[140:141]
    v_pk_mul_f32 v[142:143], v[142:143], v[142:143]
    v_cvt_pk_bf16_f32 v144, v128, v129
    v_cvt_pk_bf16_f32 v145, v130, v131
    v_cvt_pk_bf16_f32 v146, v132, v133
    v_cvt_pk_bf16_f32 v147, v134, v135
    v_cvt_pk_bf16_f32 v148, v136, v137
    v_cvt_pk_bf16_f32 v149, v138, v139
    v_cvt_pk_bf16_f32 v150, v140, v141
    v_cvt_pk_bf16_f32 v151, v142, v143
    s_mul_i32 s53, s49, 3
    s_add_u32 s53, s53, s55
    s_cmp_ge_u32 s53, 43
    s_cbranch_scc1 L_hs_1
    s_lshl_b32 s53, s53, 1
    s_lshl_b32 s54, s50, 2
    s_add_u32 s54, s54, s52
    s_mul_i32 s54, s54, 86
    s_add_u32 s53, s53, s54
    s_lshl_b32 s53, s53, 10
    s_add_u32 s53, s53, 8388608
    v_lshlrev_b32 v166, 4, v165
    buffer_store_dwordx4 v[144:147], v166, s[44:47], s53 offen sc1
    buffer_store_dwordx4 v[148:151], v166, s[44:47], s53 offen offset:1024 sc1
L_hs_1:
    s_lshl_b32 s53, s50, 2
    s_add_u32 s53, s53, s52
    s_lshl_b32 s53, s53, 5
    s_lshl_b32 s54, s49, 1
    s_add_u32 s53, s53, s54
    s_add_u32 s53, s53, s55
    s_lshl_b32 s58, s53, 10
    s_add_u32 s58, s58, 16777216
    v_mov_b64 v[124:125], 0
    v_mov_b64 v[126:127], 0
    v_mov_b64 v[152:153], 0
    v_mov_b64 v[154:155], 0
    v_mov_b64 v[156:157], 0
    v_mov_b64 v[158:159], 0
    s_waitcnt lgkmcnt(0)
    s_barrier
    s_setprio 2
    buffer_load_dwordx4 v[0:3], v160, s[44:47], s56 offen sc1
    s_mov_b64 exec, s[60:61]
    buffer_load_dwordx4 v[4:7], v162, s[44:47], s56 offen offset:1024 sc1
    buffer_load_dwordx4 v[8:11], v162, s[44:47], s56 offen offset:1536 sc1
    s_mov_b64 exec, -1
    s_add_u32 s56, s56, 8192
    s_and_b32 s56, s56, 0x1ffff
    s_waitcnt vmcnt(0)
    ds_write_b32 v164, v167
    v_mfma_f32_32x32x16_bf16 v[128:143], v[0:3], v[48:51], 0
    buffer_load_dwordx4 v[12:15], v160, s[44:47], s56 offen sc1
    s_mov_b64 exec, s[60:61]
    buffer_load_dwordx4 v[16:19], v162, s[44:47], s56 offen offset:1024 sc1
    buffer_load_dwordx4 v[20:23], v162, s[44:47], s56 offen offset:1536 sc1
    s_mov_b64 exec, -1
    s_add_u32 s56, s56, 8192
    s_and_b32 s56, s56, 0x1ffff
    buffer_load_dwordx4 v[24:27], v160, s[44:47], s56 offen sc1
    s_mov_b64 exec, s[60:61]
    buffer_load_dwordx4 v[28:31], v162, s[44:47], s56 offen offset:1024 sc1
    buffer_load_dwordx4 v[32:35], v162, s[44:47], s56 offen offset:1536 sc1
    s_mov_b64 exec, -1
    s_add_u32 s56, s56, 8192
    s_and_b32 s56, s56, 0x1ffff
.p2align 3
L_att:
    v_exp_f32 v128, v128
    v_exp_f32 v129, v129
    v_smfmac_f32_32x32x32_bf16 v[112:127], v[44:47], v[152:159], v163
    buffer_load_dwordx4 v[36:39], v160, s[44:47], s56 offen sc1
    s_mov_b64 exec, s[60:61]
    buffer_load_dwordx4 v[40:43], v162, s[44:47], s56 offen offset:1024 sc1
    buffer_load_dwordx4 v[44:47], v162, s[44:47], s56 offen offset:1536 sc1
    s_mov_b64 exec, -1
    s_add_u32 s56, s56, 8192
    s_and_b32 s56, s56, 0x1ffff
    v_exp_f32 v130, v130
    v_exp_f32 v131, v131
    v_exp_f32 v132, v132
    v_mfma_f32_32x32x16_bf16 v[144:159], v[0:3], v[52:55], 0
    v_exp_f32 v133, v133
    v_exp_f32 v134, v134
    v_exp_f32 v135, v135
    v_exp_f32 v136, v136
    v_exp_f32 v137, v137
    v_smfmac_f32_32x32x32_bf16 v[64:79], v[4:7], v[128:135], v163
    v_exp_f32 v138, v138
    v_exp_f32 v139, v139
    v_exp_f32 v140, v140
    v_exp_f32 v141, v141
    v_exp_f32 v142, v142
    v_exp_f32 v143, v143
    v_exp_f32 v144, v144
    v_exp_f32 v145, v145
    v_smfmac_f32_32x32x32_bf16 v[64:79], v[8:11], v[136:143], v163
    v_exp_f32 v146, v146
    v_exp_f32 v147, v147
    v_exp_f32 v148, v148
    v_mfma_f32_32x32x16_bf16 v[128:143], v[0:3], v[56:59], 0
    v_exp_f32 v149, v149
    v_exp_f32 v150, v150
    v_exp_f32 v151, v151
    v_exp_f32 v152, v152
    v_exp_f32 v153, v153
    v_smfmac_f32_32x32x32_bf16 v[80:95], v[4:7], v[144:151], v163
    v_exp_f32 v154, v154
    v_exp_f32 v155, v155
    v_exp_f32 v156, v156
    v_exp_f32 v157, v157
    v_exp_f32 v158, v158
    v_exp_f32 v159, v159
    v_exp_f32 v128, v128
    v_exp_f32 v129, v129
    v_smfmac_f32_32x32x32_bf16 v[80:95], v[8:11], v[152:159], v163
    v_exp_f32 v130, v130
    v_exp_f32 v131, v131
    v_exp_f32 v132, v132
    v_mfma_f32_32x32x16_bf16 v[144:159], v[0:3], v[60:63], 0
    v_exp_f32 v133, v133
    v_exp_f32 v134, v134
    v_exp_f32 v135, v135
    v_exp_f32 v136, v136
    v_exp_f32 v137, v137
    v_smfmac_f32_32x32x32_bf16 v[96:111], v[4:7], v[128:135], v163
    v_exp_f32 v138, v138
    v_exp_f32 v139, v139
    v_exp_f32 v140, v140
    v_exp_f32 v141, v141
    v_exp_f32 v142, v142
    v_exp_f32 v143, v143
    v_exp_f32 v144, v144
    v_exp_f32 v145, v145
    v_smfmac_f32_32x32x32_bf16 v[96:111], v[8:11], v[136:143], v163
    v_exp_f32 v146, v146
    v_exp_f32 v147, v147
    v_exp_f32 v148, v148
    s_waitcnt vmcnt(6)
    v_mfma_f32_32x32x16_bf16 v[128:143], v[12:15], v[48:51], 0
    v_exp_f32 v149, v149
    v_exp_f32 v150, v150
    v_exp_f32 v151, v151
    v_exp_f32 v152, v152
    v_exp_f32 v153, v153
    v_smfmac_f32_32x32x32_bf16 v[112:127], v[4:7], v[144:151], v163
    v_exp_f32 v154, v154
    v_exp_f32 v155, v155
    v_exp_f32 v156, v156
    v_exp_f32 v157, v157
    v_exp_f32 v158, v158
    v_exp_f32 v159, v159
    v_exp_f32 v128, v128
    v_exp_f32 v129, v129
    v_smfmac_f32_32x32x32_bf16 v[112:127], v[8:11], v[152:159], v163
    buffer_load_dwordx4 v[0:3], v160, s[44:47], s56 offen sc1
    s_mov_b64 exec, s[60:61]
    buffer_load_dwordx4 v[4:7], v162, s[44:47], s56 offen offset:1024 sc1
    buffer_load_dwordx4 v[8:11], v162, s[44:47], s56 offen offset:1536 sc1
    s_mov_b64 exec, -1
    s_add_u32 s56, s56, 8192
    s_and_b32 s56, s56, 0x1ffff
    v_exp_f32 v130, v130
    v_exp_f32 v131, v131
    v_exp_f32 v132, v132
    v_mfma_f32_32x32x16_bf16 v[144:159], v[12:15], v[52:55], 0
    v_exp_f32 v133, v133
    v_exp_f32 v134, v134
    v_exp_f32 v135, v135
    v_exp_f32 v136, v136
    v_exp_f32 v137, v137
    v_smfmac_f32_32x32x32_bf16 v[64:79], v[16:19], v[128:135], v163
    v_exp_f32 v138, v138
    v_exp_f32 v139, v139
    v_exp_f32 v140, v140
    v_exp_f32 v141, v141
    v_exp_f32 v142, v142
    v_exp_f32 v143, v143
    v_exp_f32 v144, v144
    v_exp_f32 v145, v145
    v_smfmac_f32_32x32x32_bf16 v[64:79], v[20:23], v[136:143], v163
    v_exp_f32 v146, v146
    v_exp_f32 v147, v147
    v_exp_f32 v148, v148
    v_mfma_f32_32x32x16_bf16 v[128:143], v[12:15], v[56:59], 0
    v_exp_f32 v149, v149
    v_exp_f32 v150, v150
    v_exp_f32 v151, v151
    v_exp_f32 v152, v152
    v_exp_f32 v153, v153
    v_smfmac_f32_32x32x32_bf16 v[80:95], v[16:19], v[144:151], v163
    v_exp_f32 v154, v154
    v_exp_f32 v155, v155
    v_exp_f32 v156, v156
    v_exp_f32 v157, v157
    v_exp_f32 v158, v158
    v_exp_f32 v159, v159
    v_exp_f32 v128, v128
    v_exp_f32 v129, v129
    v_smfmac_f32_32x32x32_bf16 v[80:95], v[20:23], v[152:159], v163
    v_exp_f32 v130, v130
    v_exp_f32 v131, v131
    v_exp_f32 v132, v132
    v_mfma_f32_32x32x16_bf16 v[144:159], v[12:15], v[60:63], 0
    v_exp_f32 v133, v133
    v_exp_f32 v134, v134
    v_exp_f32 v135, v135
    v_exp_f32 v136, v136
    v_exp_f32 v137, v137
    v_smfmac_f32_32x32x32_bf16 v[96:111], v[16:19], v[128:135], v163
    v_exp_f32 v138, v138
    v_exp_f32 v139, v139
    v_exp_f32 v140, v140
    v_exp_f32 v141, v141
    v_exp_f32 v142, v142
    v_exp_f32 v143, v143
    v_exp_f32 v144, v144
    v_exp_f32 v145, v145
    v_smfmac_f32_32x32x32_bf16 v[96:111], v[20:23], v[136:143], v163
    v_exp_f32 v146, v146
    v_exp_f32 v147, v147
    v_exp_f32 v148, v148
    s_waitcnt vmcnt(6)
    v_mfma_f32_32x32x16_bf16 v[128:143], v[24:27], v[48:51], 0
    s_cmp_lg_u32 s62, 4
    s_cbranch_scc1 L_ap1
    s_setprio 1
L_ap1:
    v_exp_f32 v149, v149
    v_exp_f32 v150, v150
    v_exp_f32 v151, v151
    v_exp_f32 v152, v152
    v_exp_f32 v153, v153
    v_smfmac_f32_32x32x32_bf16 v[112:127], v[16:19], v[144:151], v163
    v_exp_f32 v154, v154
    v_exp_f32 v155, v155
    v_exp_f32 v156, v156
    v_exp_f32 v157, v157
    v_exp_f32 v158, v158
    v_exp_f32 v159, v159
    v_exp_f32 v128, v128
    v_exp_f32 v129, v129
    v_smfmac_f32_32x32x32_bf16 v[112:127], v[20:23], v[152:159], v163
    buffer_load_dwordx4 v[12:15], v160, s[44:47], s56 offen sc1
    s_mov_b64 exec, s[60:61]
    buffer_load_dwordx4 v[16:19], v162, s[44:47], s56 offen offset:1024 sc1
    buffer_load_dwordx4 v[20:23], v162, s[44:47], s56 offen offset:1536 sc1
    s_mov_b64 exec, -1
    s_add_u32 s56, s56, 8192
    s_and_b32 s56, s56, 0x1ffff
    v_exp_f32 v130, v130
    v_exp_f32 v131, v131
    v_exp_f32 v132, v132
    v_mfma_f32_32x32x16_bf16 v[144:159], v[24:27], v[52:55], 0
    v_exp_f32 v133, v133
    v_exp_f32 v134, v134
    v_exp_f32 v135, v135
    v_exp_f32 v136, v136
    v_exp_f32 v137, v137
    v_smfmac_f32_32x32x32_bf16 v[64:79], v[28:31], v[128:135], v163
    s_cmp_lg_u32 s62, 1
    s_cbranch_scc1 L_ap2
    s_setprio 0
L_ap2:
    v_exp_f32 v138, v138
    v_exp_f32 v139, v139
    v_exp_f32 v140, v140
    v_exp_f32 v141, v141
    v_exp_f32 v142, v142
    v_exp_f32 v143, v143
    v_exp_f32 v144, v144
    v_exp_f32 v145, v145
    v_smfmac_f32_32x32x32_bf16 v[64:79], v[32:35], v[136:143], v163
    v_exp_f32 v146, v146
    v_exp_f32 v147, v147
    v_exp_f32 v148, v148
    v_mfma_f32_32x32x16_bf16 v[128:143], v[24:27], v[56:59], 0
    v_exp_f32 v149, v149
    v_exp_f32 v150, v150
    v_exp_f32 v151, v151
    v_exp_f32 v152, v152
    v_exp_f32 v153, v153
    v_smfmac_f32_32x32x32_bf16 v[80:95], v[28:31], v[144:151], v163
    v_exp_f32 v154, v154
    v_exp_f32 v155, v155
    v_exp_f32 v156, v156
    v_exp_f32 v157, v157
    v_exp_f32 v158, v158
    v_exp_f32 v159, v159
    v_exp_f32 v128, v128
    v_exp_f32 v129, v129
    v_smfmac_f32_32x32x32_bf16 v[80:95], v[32:35], v[152:159], v163
    v_exp_f32 v130, v130
    v_exp_f32 v131, v131
    v_exp_f32 v132, v132
    v_mfma_f32_32x32x16_bf16 v[144:159], v[24:27], v[60:63], 0
    v_exp_f32 v133, v133
    v_exp_f32 v134, v134
    v_exp_f32 v135, v135
    v_exp_f32 v136, v136
    v_exp_f32 v137, v137
    v_smfmac_f32_32x32x32_bf16 v[96:111], v[28:31], v[128:135], v163
    v_exp_f32 v138, v138
    v_exp_f32 v139, v139
    v_exp_f32 v140, v140
    v_exp_f32 v141, v141
    v_exp_f32 v142, v142
    v_exp_f32 v143, v143
    v_exp_f32 v144, v144
    v_exp_f32 v145, v145
    v_smfmac_f32_32x32x32_bf16 v[96:111], v[32:35], v[136:143], v163
    v_exp_f32 v146, v146
    v_exp_f32 v147, v147
    v_exp_f32 v148, v148
    s_waitcnt vmcnt(6)
    v_mfma_f32_32x32x16_bf16 v[128:143], v[36:39], v[48:51], 0
    v_exp_f32 v149, v149
    v_exp_f32 v150, v150
    v_exp_f32 v151, v151
    v_exp_f32 v152, v152
    v_exp_f32 v153, v153
    v_smfmac_f32_32x32x32_bf16 v[112:127], v[28:31], v[144:151], v163
    v_exp_f32 v154, v154
    v_exp_f32 v155, v155
    v_exp_f32 v156, v156
    v_exp_f32 v157, v157
    v_exp_f32 v158, v158
    v_exp_f32 v159, v159
    v_exp_f32 v128, v128
    v_exp_f32 v129, v129
    v_smfmac_f32_32x32x32_bf16 v[112:127], v[32:35], v[152:159], v163
    buffer_load_dwordx4 v[24:27], v160, s[44:47], s56 offen sc1
    s_mov_b64 exec, s[60:61]
    buffer_load_dwordx4 v[28:31], v162, s[44:47], s56 offen offset:1024 sc1
    buffer_load_dwordx4 v[32:35], v162, s[44:47], s56 offen offset:1536 sc1
    s_mov_b64 exec, -1
    s_add_u32 s56, s56, 8192
    s_and_b32 s56, s56, 0x1ffff
    v_exp_f32 v130, v130
    v_exp_f32 v131, v131
    v_exp_f32 v132, v132
    v_mfma_f32_32x32x16_bf16 v[144:159], v[36:39], v[52:55], 0
    v_exp_f32 v133, v133
    v_exp_f32 v134, v134
    v_exp_f32 v135, v135
    v_exp_f32 v136, v136
    v_exp_f32 v137, v137
    v_smfmac_f32_32x32x32_bf16 v[64:79], v[40:43], v[128:135], v163
    v_exp_f32 v138, v138
    v_exp_f32 v139, v139
    v_exp_f32 v140, v140
    v_exp_f32 v141, v141
    v_exp_f32 v142, v142
    v_exp_f32 v143, v143
    v_exp_f32 v144, v144
    v_exp_f32 v145, v145
    v_smfmac_f32_32x32x32_bf16 v[64:79], v[44:47], v[136:143], v163
    v_exp_f32 v146, v146
    v_exp_f32 v147, v147
    v_exp_f32 v148, v148
    v_mfma_f32_32x32x16_bf16 v[128:143], v[36:39], v[56:59], 0
    v_exp_f32 v149, v149
    v_exp_f32 v150, v150
    v_exp_f32 v151, v151
    v_exp_f32 v152, v152
    v_exp_f32 v153, v153
    v_smfmac_f32_32x32x32_bf16 v[80:95], v[40:43], v[144:151], v163
    v_exp_f32 v154, v154
    v_exp_f32 v155, v155
    v_exp_f32 v156, v156
    v_exp_f32 v157, v157
    v_exp_f32 v158, v158
    v_exp_f32 v159, v159
    v_exp_f32 v128, v128
    v_exp_f32 v129, v129
    v_smfmac_f32_32x32x32_bf16 v[80:95], v[44:47], v[152:159], v163
    v_exp_f32 v130, v130
    v_exp_f32 v131, v131
    v_exp_f32 v132, v132
    v_mfma_f32_32x32x16_bf16 v[144:159], v[36:39], v[60:63], 0
    v_exp_f32 v133, v133
    v_exp_f32 v134, v134
    v_exp_f32 v135, v135
    v_exp_f32 v136, v136
    v_exp_f32 v137, v137
    v_smfmac_f32_32x32x32_bf16 v[96:111], v[40:43], v[128:135], v163
    v_exp_f32 v138, v138
    v_exp_f32 v139, v139
    v_exp_f32 v140, v140
    v_exp_f32 v141, v141
    v_exp_f32 v142, v142
    v_exp_f32 v143, v143
    v_exp_f32 v144, v144
    v_exp_f32 v145, v145
    v_smfmac_f32_32x32x32_bf16 v[96:111], v[44:47], v[136:143], v163
    v_exp_f32 v146, v146
    v_exp_f32 v147, v147
    v_exp_f32 v148, v148
    s_waitcnt vmcnt(6)
    v_mfma_f32_32x32x16_bf16 v[128:143], v[0:3], v[48:51], 0
    v_exp_f32 v149, v149
    v_exp_f32 v150, v150
    v_exp_f32 v151, v151
    v_exp_f32 v152, v152
    v_exp_f32 v153, v153
    v_smfmac_f32_32x32x32_bf16 v[112:127], v[40:43], v[144:151], v163
    s_sub_u32 s62, s62, 1
    s_cmp_lg_u32 s62, 0
    v_exp_f32 v154, v154
    v_exp_f32 v155, v155
    v_exp_f32 v156, v156
    v_exp_f32 v157, v157
    v_exp_f32 v158, v158
    v_exp_f32 v159, v159
    s_cbranch_scc1 L_att
    s_nop 1
    v_smfmac_f32_32x32x32_bf16 v[112:127], v[44:47], v[152:159], v163
    s_add_u32 s53, s52, 1
    s_and_b32 s53, s53, 3
    s_lshl_b32 s54, s55, 2
    s_add_u32 s53, s53, s54
    s_mul_i32 s53, s53, 6912
    s_add_u32 s53, s53, 0
    v_lshl_add_u32 v129, v165, 4, s53
    v_lshl_add_u32 v133, v165, 2, s53
    s_add_u32 s53, s52, 2
    s_and_b32 s53, s53, 3
    s_lshl_b32 s54, s55, 2
    s_add_u32 s53, s53, s54
    s_mul_i32 s53, s53, 6912
    s_add_u32 s53, s53, 2304
    v_lshl_add_u32 v130, v165, 4, s53
    v_lshl_add_u32 v134, v165, 2, s53
    s_add_u32 s53, s52, 3
    s_and_b32 s53, s53, 3
    s_lshl_b32 s54, s55, 2
    s_add_u32 s53, s53, s54
    s_mul_i32 s53, s53, 6912
    s_add_u32 s53, s53, 4608
    v_lshl_add_u32 v131, v165, 4, s53
    v_lshl_add_u32 v135, v165, 2, s53
    s_nop 3
    ds_write_b128 v129, v[80:83]
    ds_write_b128 v129, v[84:87] offset:1024
    ds_write_b32 v133, v88 offset:2048
    ds_write_b128 v130, v[96:99]
    ds_write_b128 v130, v[100:103] offset:1024
    ds_write_b32 v134, v104 offset:2048
    ds_write_b128 v131, v[112:115]
    ds_write_b128 v131, v[116:119] offset:1024
    ds_write_b32 v135, v120 offset:2048
    s_mul_i32 s53, s48, 6912
    v_lshl_add_u32 v128, v165, 4, s53
    v_lshl_add_u32 v132, v165, 2, s53
    v_and_b32 v136, 31, v165
    s_lshl_b32 s53, s52, 7
    s_add_u32 s53, s53, 163072
    v_lshl_add_u32 v136, v136, 2, s53
    s_waitcnt lgkmcnt(0)
    s_barrier
    ds_read_b128 v[80:83], v128 offset:0
    ds_read_b128 v[84:87], v128 offset:1024
    ds_read_b32 v88, v132 offset:2048
    ds_read_b128 v[96:99], v128 offset:2304
    ds_read_b128 v[100:103], v128 offset:3328
    ds_read_b32 v104, v132 offset:4352
    ds_read_b128 v[112:115], v128 offset:4608
    ds_read_b128 v[116:119], v128 offset:5632
    ds_read_b32 v120, v132 offset:6656
    ds_read_b32 v137, v136
    v_lshlrev_b32 v138, 4, v165
    s_waitcnt lgkmcnt(7)
    v_add_f32 v64, v64, v80
    v_add_f32 v65, v65, v81
    v_add_f32 v66, v66, v82
    v_add_f32 v67, v67, v83
    v_add_f32 v68, v68, v84
    v_add_f32 v69, v69, v85
    v_add_f32 v70, v70, v86
    v_add_f32 v71, v71, v87
    v_add_f32 v72, v72, v88
    s_waitcnt lgkmcnt(4)
    v_add_f32 v64, v64, v96
    v_add_f32 v65, v65, v97
    v_add_f32 v66, v66, v98
    v_add_f32 v67, v67, v99
    v_add_f32 v68, v68, v100
    v_add_f32 v69, v69, v101
    v_add_f32 v70, v70, v102
    v_add_f32 v71, v71, v103
    v_add_f32 v72, v72, v104
    s_waitcnt lgkmcnt(1)
    v_add_f32 v64, v64, v112
    v_add_f32 v65, v65, v113
    v_add_f32 v66, v66, v114
    v_add_f32 v67, v67, v115
    v_add_f32 v68, v68, v116
    v_add_f32 v69, v69, v117
    v_add_f32 v70, v70, v118
    v_add_f32 v71, v71, v119
    v_add_f32 v72, v72, v120
    v_mul_f32 v139, 0, v64
    v_fmac_f32 v139, 0, v65
    v_fmac_f32 v139, 0, v66
    v_fmac_f32 v139, 0, v67
    v_fmac_f32 v139, 0, v68
    v_fmac_f32 v139, 0, v69
    v_fmac_f32 v139, 0, v70
    v_fmac_f32 v139, 0, v71
    v_add_f32 v139, v139, v72
    v_mov_b32 v140, 0x53800000
    v_cmp_nle_f32 vcc, 0x2b800000, v139
    v_cmp_nge_f32 s[54:55], v140, v139
    s_nop 0
    s_or_b64 vcc, vcc, s[54:55]
    s_cbranch_vccnz L_fb
L_fbdone:
    v_rcp_f32 v139, v72
    s_waitcnt lgkmcnt(0)
    v_mul_f32 v139, v139, v137
    v_mul_f32 v64, v64, v139
    v_mul_f32 v65, v65, v139
    v_mul_f32 v66, v66, v139
    v_mul_f32 v67, v67, v139
    v_mul_f32 v68, v68, v139
    v_mul_f32 v69, v69, v139
    v_mul_f32 v70, v70, v139
    v_mul_f32 v71, v71, v139
    v_cvt_pk_bf16_f32 v64, v64, v65
    v_cvt_pk_bf16_f32 v65, v66, v67
    v_cvt_pk_bf16_f32 v66, v68, v69
    v_cvt_pk_bf16_f32 v67, v70, v71
    v_min_u32 v64, -2, v64
    v_min_u32 v65, -2, v65
    v_min_u32 v66, -2, v66
    v_min_u32 v67, -2, v67
    buffer_store_dwordx4 v[64:67], v138, s[44:47], s58 offen sc1
    s_waitcnt vmcnt(1)
    v_lshrrev_b32 v16, 3, v165
    s_lshl_b32 s53, s48, 3
    v_add_u32 v16, s53, v16
    v_and_b32 v17, 7, v165
    s_lshr_b32 s53, s49, 1
    s_lshl_b32 s53, s53, 7
    v_lshl_add_u32 v18, v17, 4, s53
    buffer_load_dwordx4 v[24:27], v18, s[28:31], 0 offen
    s_and_b32 s54, s49, 1
    s_lshl_b32 s54, s54, 6
    v_add_u32 v19, s54, v16
    v_lshlrev_b32 v20, 2, v19
    v_add_u32 v20, 163072, v20
    ds_read_b32 v137, v20
    s_lshl_b32 s54, s50, 7
    v_add_u32 v19, s54, v19
    v_lshl_add_u32 v22, v19, 10, v18
    v_lshlrev_b32 v18, 1, v17
    v_and_b32 v19, 15, v16
    v_xor_b32 v18, v18, v19
    v_lshlrev_b32 v18, 4, v18
    v_lshl_add_u32 v18, v16, 8, v18
    v_add_u32 v18, 55296, v18
    v_xor_b32 v19, 16, v18
    s_waitcnt vmcnt(0) lgkmcnt(0)
    v_sub_f32 v137, 1.0, v137
    v_lshlrev_b32 v32, 16, v24
    v_and_b32 v33, 0xffff0000, v24
    v_lshlrev_b32 v34, 16, v25
    v_and_b32 v35, 0xffff0000, v25
    v_lshlrev_b32 v36, 16, v26
    v_and_b32 v37, 0xffff0000, v26
    v_lshlrev_b32 v38, 16, v27
    v_and_b32 v39, 0xffff0000, v27
    v_mul_f32 v32, v32, v137
    v_mul_f32 v33, v33, v137
    v_mul_f32 v34, v34, v137
    v_mul_f32 v35, v35, v137
    v_mul_f32 v36, v36, v137
    v_mul_f32 v37, v37, v137
    v_mul_f32 v38, v38, v137
    v_mul_f32 v39, v39, v137
    s_barrier
    ds_read_b128 v[64:67], v18 offset:0
    ds_read_b128 v[68:71], v19 offset:0
    ds_read_b128 v[72:75], v18 offset:16384
    ds_read_b128 v[76:79], v19 offset:16384
    ds_read_b128 v[80:83], v18 offset:32768
    ds_read_b128 v[84:87], v19 offset:32768
    ds_read_b128 v[88:91], v18 offset:49152
    ds_read_b128 v[92:95], v19 offset:49152
    s_waitcnt lgkmcnt(6)
    v_add_f32 v32, v32, v64
    v_add_f32 v33, v33, v65
    v_add_f32 v34, v34, v66
    v_add_f32 v35, v35, v67
    v_add_f32 v36, v36, v68
    v_add_f32 v37, v37, v69
    v_add_f32 v38, v38, v70
    v_add_f32 v39, v39, v71
    s_waitcnt lgkmcnt(4)
    v_add_f32 v32, v32, v72
    v_add_f32 v33, v33, v73
    v_add_f32 v34, v34, v74
    v_add_f32 v35, v35, v75
    v_add_f32 v36, v36, v76
    v_add_f32 v37, v37, v77
    v_add_f32 v38, v38, v78
    v_add_f32 v39, v39, v79
    s_waitcnt lgkmcnt(2)
    v_add_f32 v32, v32, v80
    v_add_f32 v33, v33, v81
    v_add_f32 v34, v34, v82
    v_add_f32 v35, v35, v83
    v_add_f32 v36, v36, v84
    v_add_f32 v37, v37, v85
    v_add_f32 v38, v38, v86
    v_add_f32 v39, v39, v87
    s_waitcnt lgkmcnt(0)
    v_add_f32 v32, v32, v88
    v_add_f32 v33, v33, v89
    v_add_f32 v34, v34, v90
    v_add_f32 v35, v35, v91
    v_add_f32 v36, v36, v92
    v_add_f32 v37, v37, v93
    v_add_f32 v38, v38, v94
    v_add_f32 v39, v39, v95
    v_cvt_pk_bf16_f32 v32, v32, v33
    v_cvt_pk_bf16_f32 v33, v34, v35
    v_cvt_pk_bf16_f32 v34, v36, v37
    v_cvt_pk_bf16_f32 v35, v38, v39
    buffer_store_dwordx4 v[32:35], v22, s[36:39], 0 offen
    s_branch L_end
L_fb:
    s_waitcnt vmcnt(0) lgkmcnt(0)
    s_lshl_b32 s53, s52, 11
    v_subrev_u32 v160, s53, v160
    v_subrev_u32 v162, s53, v162
    v_mov_b32 v144, 0xff800000
    s_mov_b32 s56, 0
L_fb1:
    buffer_load_dwordx4 v[0:3], v160, s[44:47], s56 offen sc1
    s_waitcnt vmcnt(0)
    v_mfma_f32_32x32x16_bf16 v[96:111], v[0:3], v[48:51], 0
    s_nop 7
    s_nop 3
    v_max3_f32 v144, v96, v97, v144
    v_max3_f32 v144, v98, v99, v144
    v_max3_f32 v144, v100, v101, v144
    v_max3_f32 v144, v102, v103, v144
    v_max3_f32 v144, v104, v105, v144
    v_max3_f32 v144, v106, v107, v144
    v_max3_f32 v144, v108, v109, v144
    v_max3_f32 v144, v110, v111, v144
    s_add_u32 s56, s56, 2048
    s_cmp_lg_u32 s56, 131072
    s_cbranch_scc1 L_fb1
    v_mov_b32 v145, v144
    s_nop 1
    v_permlane32_swap_b32 v144, v145
    s_nop 1
    v_max_f32 v144, v144, v145
    v_sub_f32 v112, 0, v144
    v_mov_b32 v64, 0
    v_sub_f32 v113, 0, v144
    v_mov_b32 v65, 0
    v_sub_f32 v114, 0, v144
    v_mov_b32 v66, 0
    v_sub_f32 v115, 0, v144
    v_mov_b32 v67, 0
    v_sub_f32 v116, 0, v144
    v_mov_b32 v68, 0
    v_sub_f32 v117, 0, v144
    v_mov_b32 v69, 0
    v_sub_f32 v118, 0, v144
    v_mov_b32 v70, 0
    v_sub_f32 v119, 0, v144
    v_mov_b32 v71, 0
    v_sub_f32 v120, 0, v144
    v_mov_b32 v72, 0
    v_sub_f32 v121, 0, v144
    v_mov_b32 v73, 0
    v_sub_f32 v122, 0, v144
    v_mov_b32 v74, 0
    v_sub_f32 v123, 0, v144
    v_mov_b32 v75, 0
    v_sub_f32 v124, 0, v144
    v_mov_b32 v76, 0
    v_sub_f32 v125, 0, v144
    v_mov_b32 v77, 0
    v_sub_f32 v126, 0, v144
    v_mov_b32 v78, 0
    v_sub_f32 v127, 0, v144
    v_mov_b32 v79, 0
    s_mov_b32 s56, 0
L_fb2:
    buffer_load_dwordx4 v[0:3], v160, s[44:47], s56 offen sc1
    s_mov_b64 exec, s[60:61]
    buffer_load_dwordx4 v[4:7], v162, s[44:47], s56 offen offset:1024 sc1
    buffer_load_dwordx4 v[8:11], v162, s[44:47], s56 offen offset:1536 sc1
    s_mov_b64 exec, -1
    s_waitcnt vmcnt(0)
    v_mfma_f32_32x32x16_bf16 v[96:111], v[0:3], v[48:51], v[112:127]
    s_nop 7
    s_nop 3
    v_exp_f32 v96, v96
    v_exp_f32 v97, v97
    v_exp_f32 v98, v98
    v_exp_f32 v99, v99
    v_exp_f32 v100, v100
    v_exp_f32 v101, v101
    v_exp_f32 v102, v102
    v_exp_f32 v103, v103
    v_exp_f32 v104, v104
    v_exp_f32 v105, v105
    v_exp_f32 v106, v106
    v_exp_f32 v107, v107
    v_exp_f32 v108, v108
    v_exp_f32 v109, v109
    v_exp_f32 v110, v110
    v_exp_f32 v111, v111
    s_nop 1
    v_smfmac_f32_32x32x32_bf16 v[64:79], v[4:7], v[96:103], v163
    v_smfmac_f32_32x32x32_bf16 v[64:79], v[8:11], v[104:111], v163
    s_add_u32 s56, s56, 2048
    s_cmp_lg_u32 s56, 131072
    s_cbranch_scc1 L_fb2
    s_nop 7
    s_nop 3
    s_branch L_fbdone
L_roleQ:
    s_load_dwordx2 s[40:41], s[0:1], 80
    s_load_dwordx2 s[12:13], s[0:1], 32
    s_load_dwordx2 s[20:21], s[0:1], 16
    s_load_dwordx2 s[16:17], s[0:1], 48
    s_load_dwordx2 s[28:29], s[0:1], 56
    s_load_dwordx2 s[36:37], s[0:1], 72
    s_mov_b32 s42, 256
    s_mov_b32 s43, s7
    s_mov_b32 s14, 1409024
    s_mov_b32 s15, s7
    s_mov_b32 s22, 524288
    s_mov_b32 s23, s7
    s_mov_b32 s18, 1409024
    s_mov_b32 s19, s7
    s_mov_b32 s30, 1024
    s_mov_b32 s31, s7
    s_mov_b32 s38, 2097152
    s_mov_b32 s39, s7
    s_lshl_b32 s53, s48, 6
    v_add_u32 v166, s53, v165
    v_mul_u32_u24 v167, 43691, v166
    s_mul_i32 s53, s49, 192
    v_lshrrev_b32 v167, 19, v167
    s_movk_i32 s54, 2752
    v_mad_i32_i24 v166, v167, -12, v166
    v_lshl_add_u32 v166, v166, 4, s53
    v_min_u32 v166, 2736, v166
    v_mad_u32_u24 v164, v167, s54, v166
    s_mov_b32 s53, 24576
    v_lshrrev_b32 v1, 5, v165
    v_bfe_u32 v2, v165, 2, 2
    v_lshl_add_u32 v1, v1, 3, v2
    v_mul_u32_u24 v1, 64, v1
    v_add_u32 v1, s53, v1
    v_bfe_u32 v2, v165, 4, 1
    v_lshl_add_u32 v1, v2, 5, v1
    v_and_b32 v2, 3, v165
    v_lshl_add_u32 v161, v2, 3, v1
    s_waitcnt lgkmcnt(0)
    s_waitcnt vmcnt(1)
    s_cmp_lg_u32 s48, 11
    s_cbranch_scc1 L_q2
    s_cmp_lg_u32 s2, 0
    s_cbranch_scc1 L_q2
    v_mov_b32 v4, 1
    s_mov_b64 exec, 1
    buffer_store_dword v4, v3, s[40:43], 0 offen sc1
    s_mov_b64 exec, -1
L_q2:
    s_barrier
    ds_read_b64_tr_b16 v[144:145], v161 offset:0
    ds_read_b64_tr_b16 v[146:147], v161 offset:256
    ds_read_b128 v[0:3], v160 offset:0
    v_xor_b32 v160, 32, v160
    s_add_u32 s53, s51, 2
    s_and_b32 s53, s53, 7
    s_mul_i32 s53, s53, 196608
    s_add_u32 m0, s59, 81920
    s_nop 0
    buffer_load_dwordx4 v162, s[8:11], s53 offen lds
    ds_read_b64_tr_b16 v[148:149], v161 offset:1024
    ds_read_b64_tr_b16 v[150:151], v161 offset:1280
    ds_read_b128 v[4:7], v160 offset:0
    v_xor_b32 v160, 96, v160
    ds_read_b64_tr_b16 v[152:153], v161 offset:2048
    ds_read_b64_tr_b16 v[154:155], v161 offset:2304
    ds_read_b128 v[8:11], v160 offset:0
    v_xor_b32 v160, 32, v160
    ds_read_b64_tr_b16 v[156:157], v161 offset:3072
    ds_read_b64_tr_b16 v[158:159], v161 offset:3328
    ds_read_b128 v[12:15], v160 offset:0
    v_xor_b32 v160, 96, v160
    s_waitcnt lgkmcnt(0)
    s_waitcnt vmcnt(1)
    s_barrier
    v_mfma_f32_32x32x16_bf16 v[128:143], v[144:147], v[0:3], 0
    ds_read_b64_tr_b16 v[144:145], v161 offset:28672
    ds_read_b64_tr_b16 v[146:147], v161 offset:28928
    ds_read_b128 v[16:19], v160 offset:28672
    v_xor_b32 v160, 32, v160
    s_add_u32 s53, s51, 3
    s_and_b32 s53, s53, 7
    s_mul_i32 s53, s53, 196608
    s_add_u32 m0, s59, 24576
    s_nop 0
    buffer_load_dwordx4 v162, s[8:11], s53 offen lds
    v_mfma_f32_32x32x16_bf16 v[128:143], v[148:151], v[4:7], v[128:143]
    ds_read_b64_tr_b16 v[148:149], v161 offset:29696
    ds_read_b64_tr_b16 v[150:151], v161 offset:29952
    ds_read_b128 v[20:23], v160 offset:28672
    v_xor_b32 v160, 96, v160
    v_mfma_f32_32x32x16_bf16 v[128:143], v[152:155], v[8:11], v[128:143]
    ds_read_b64_tr_b16 v[152:153], v161 offset:30720
    ds_read_b64_tr_b16 v[154:155], v161 offset:30976
    ds_read_b128 v[24:27], v160 offset:28672
    v_xor_b32 v160, 32, v160
    v_mfma_f32_32x32x16_bf16 v[128:143], v[156:159], v[12:15], v[128:143]
    ds_read_b64_tr_b16 v[156:157], v161 offset:31744
    ds_read_b64_tr_b16 v[158:159], v161 offset:32000
    ds_read_b128 v[28:31], v160 offset:28672
    v_xor_b32 v160, 96, v160
    s_waitcnt lgkmcnt(0)
    s_waitcnt vmcnt(1)
    s_barrier
    v_add_u32 v161, 57344, v161
    v_mfma_f32_32x32x16_bf16 v[128:143], v[144:147], v[16:19], v[128:143]
    ds_read_b64_tr_b16 v[144:145], v161 offset:0
    ds_read_b64_tr_b16 v[146:147], v161 offset:256
    ds_read_b128 v[32:35], v160 offset:57344
    v_xor_b32 v160, 32, v160
    s_add_u32 s53, s51, 4
    s_and_b32 s53, s53, 7
    s_mul_i32 s53, s53, 196608
    s_add_u32 m0, s59, 53248
    s_nop 0
    buffer_load_dwordx4 v162, s[8:11], s53 offen lds
    v_mfma_f32_32x32x16_bf16 v[128:143], v[148:151], v[20:23], v[128:143]
    ds_read_b64_tr_b16 v[148:149], v161 offset:1024
    ds_read_b64_tr_b16 v[150:151], v161 offset:1280
    ds_read_b128 v[36:39], v160 offset:57344
    v_xor_b32 v160, 96, v160
    s_lshl_b32 s53, s50, 2
    s_add_u32 s53, s53, s52
    s_lshl_b32 s53, s53, 4
    s_add_u32 s53, s53, s49
    s_lshl_b32 s53, s53, 11
    s_add_u32 s53, s53, 16777216
    v_lshlrev_b32 v116, 4, v165
    v_mov_b64 v[112:113], -1
    v_mov_b64 v[114:115], -1
    buffer_store_dwordx4 v[112:115], v116, s[44:47], s53 offen sc1
    buffer_store_dwordx4 v[112:115], v116, s[44:47], s53 offen offset:1024 sc1
    v_mfma_f32_32x32x16_bf16 v[128:143], v[152:155], v[24:27], v[128:143]
    ds_read_b64_tr_b16 v[152:153], v161 offset:2048
    ds_read_b64_tr_b16 v[154:155], v161 offset:2304
    ds_read_b128 v[40:43], v160 offset:57344
    v_xor_b32 v160, 32, v160
    v_mfma_f32_32x32x16_bf16 v[128:143], v[156:159], v[28:31], v[128:143]
    ds_read_b64_tr_b16 v[156:157], v161 offset:3072
    ds_read_b64_tr_b16 v[158:159], v161 offset:3328
    ds_read_b128 v[44:47], v160 offset:57344
    v_xor_b32 v160, 96, v160
    s_waitcnt lgkmcnt(0)
    s_waitcnt vmcnt(3)
    s_barrier
    v_add_u32 v161, 4294909952, v161
    v_mfma_f32_32x32x16_bf16 v[128:143], v[144:147], v[32:35], v[128:143]
    ds_read_b64_tr_b16 v[144:145], v161 offset:0
    ds_read_b64_tr_b16 v[146:147], v161 offset:256
    ds_read_b128 v[48:51], v160 offset:0
    v_xor_b32 v160, 32, v160
    s_add_u32 s53, s51, 5
    s_and_b32 s53, s53, 7
    s_mul_i32 s53, s53, 196608
    s_add_u32 m0, s59, 81920
    s_nop 0
    buffer_load_dwordx4 v162, s[8:11], s53 offen lds
    v_mfma_f32_32x32x16_bf16 v[128:143], v[148:151], v[36:39], v[128:143]
    ds_read_b64_tr_b16 v[148:149], v161 offset:1024
    ds_read_b64_tr_b16 v[150:151], v161 offset:1280
    ds_read_b128 v[52:55], v160 offset:0
    v_xor_b32 v160, 96, v160
    v_mfma_f32_32x32x16_bf16 v[128:143], v[152:155], v[40:43], v[128:143]
    ds_read_b64_tr_b16 v[152:153], v161 offset:2048
    ds_read_b64_tr_b16 v[154:155], v161 offset:2304
    ds_read_b128 v[56:59], v160 offset:0
    v_xor_b32 v160, 32, v160
    v_mfma_f32_32x32x16_bf16 v[128:143], v[156:159], v[44:47], v[128:143]
    ds_read_b64_tr_b16 v[156:157], v161 offset:3072
    ds_read_b64_tr_b16 v[158:159], v161 offset:3328
    ds_read_b128 v[60:63], v160 offset:0
    v_xor_b32 v160, 96, v160
    s_waitcnt lgkmcnt(0)
    s_waitcnt vmcnt(3)
    s_barrier
    v_mfma_f32_32x32x16_bf16 v[128:143], v[144:147], v[48:51], v[128:143]
    ds_read_b64_tr_b16 v[144:145], v161 offset:28672
    ds_read_b64_tr_b16 v[146:147], v161 offset:28928
    ds_read_b128 v[64:67], v160 offset:28672
    v_xor_b32 v160, 32, v160
    s_add_u32 s53, s51, 6
    s_and_b32 s53, s53, 7
    s_mul_i32 s53, s53, 196608
    s_add_u32 m0, s59, 24576
    s_nop 0
    buffer_load_dwordx4 v162, s[8:11], s53 offen lds
    v_mfma_f32_32x32x16_bf16 v[128:143], v[148:151], v[52:55], v[128:143]
    ds_read_b64_tr_b16 v[148:149], v161 offset:29696
    ds_read_b64_tr_b16 v[150:151], v161 offset:29952
    ds_read_b128 v[68:71], v160 offset:28672
    v_xor_b32 v160, 96, v160
    v_mfma_f32_32x32x16_bf16 v[128:143], v[152:155], v[56:59], v[128:143]
    ds_read_b64_tr_b16 v[152:153], v161 offset:30720
    ds_read_b64_tr_b16 v[154:155], v161 offset:30976
    ds_read_b128 v[72:75], v160 offset:28672
    v_xor_b32 v160, 32, v160
    v_mfma_f32_32x32x16_bf16 v[128:143], v[156:159], v[60:63], v[128:143]
    ds_read_b64_tr_b16 v[156:157], v161 offset:31744
    ds_read_b64_tr_b16 v[158:159], v161 offset:32000
    ds_read_b128 v[76:79], v160 offset:28672
    v_xor_b32 v160, 96, v160
    s_waitcnt lgkmcnt(0)
    s_waitcnt vmcnt(1)
    s_barrier
    v_add_u32 v161, 57344, v161
    v_mfma_f32_32x32x16_bf16 v[128:143], v[144:147], v[64:67], v[128:143]
    ds_read_b64_tr_b16 v[144:145], v161 offset:0
    ds_read_b64_tr_b16 v[146:147], v161 offset:256
    ds_read_b128 v[80:83], v160 offset:57344
    v_xor_b32 v160, 32, v160
    s_add_u32 s53, s51, 7
    s_and_b32 s53, s53, 7
    s_mul_i32 s53, s53, 196608
    s_add_u32 m0, s59, 53248
    s_nop 0
    buffer_load_dwordx4 v162, s[8:11], s53 offen lds
    v_mfma_f32_32x32x16_bf16 v[128:143], v[148:151], v[68:71], v[128:143]
    ds_read_b64_tr_b16 v[148:149], v161 offset:1024
    ds_read_b64_tr_b16 v[150:151], v161 offset:1280
    ds_read_b128 v[84:87], v160 offset:57344
    v_xor_b32 v160, 96, v160
    v_mfma_f32_32x32x16_bf16 v[128:143], v[152:155], v[72:75], v[128:143]
    ds_read_b64_tr_b16 v[152:153], v161 offset:2048
    ds_read_b64_tr_b16 v[154:155], v161 offset:2304
    ds_read_b128 v[88:91], v160 offset:57344
    v_xor_b32 v160, 32, v160
    v_mfma_f32_32x32x16_bf16 v[128:143], v[156:159], v[76:79], v[128:143]
    ds_read_b64_tr_b16 v[156:157], v161 offset:3072
    ds_read_b64_tr_b16 v[158:159], v161 offset:3328
    ds_read_b128 v[92:95], v160 offset:57344
    v_xor_b32 v160, 96, v160
    s_waitcnt lgkmcnt(0)
    s_waitcnt vmcnt(1)
    s_barrier
    v_add_u32 v161, 4294909952, v161
    v_mfma_f32_32x32x16_bf16 v[128:143], v[144:147], v[80:83], v[128:143]
    ds_read_b64_tr_b16 v[144:145], v161 offset:0
    ds_read_b64_tr_b16 v[146:147], v161 offset:256
    ds_read_b128 v[96:99], v160 offset:0
    v_xor_b32 v160, 32, v160
    s_add_u32 s53, s51, 0
    s_and_b32 s53, s53, 7
    s_mul_i32 s53, s53, 176128
    s_add_u32 m0, s56, 86016
    s_nop 0
    buffer_load_dwordx4 v164, s[12:15], s53 offen lds
    v_mfma_f32_32x32x16_bf16 v[128:143], v[148:151], v[84:87], v[128:143]
    ds_read_b64_tr_b16 v[148:149], v161 offset:1024
    ds_read_b64_tr_b16 v[150:151], v161 offset:1280
    ds_read_b128 v[100:103], v160 offset:0
    v_xor_b32 v160, 96, v160
    s_add_u32 s53, s51, 1
    s_and_b32 s53, s53, 7
    s_mul_i32 s53, s53, 176128
    s_add_u32 m0, s56, 98304
    s_nop 0
    buffer_load_dwordx4 v164, s[12:15], s53 offen lds
    v_mfma_f32_32x32x16_bf16 v[128:143], v[152:155], v[88:91], v[128:143]
    ds_read_b64_tr_b16 v[152:153], v161 offset:2048
    ds_read_b64_tr_b16 v[154:155], v161 offset:2304
    ds_read_b128 v[104:107], v160 offset:0
    v_xor_b32 v160, 32, v160
    v_mfma_f32_32x32x16_bf16 v[128:143], v[156:159], v[92:95], v[128:143]
    ds_read_b64_tr_b16 v[156:157], v161 offset:3072
    ds_read_b64_tr_b16 v[158:159], v161 offset:3328
    ds_read_b128 v[108:111], v160 offset:0
    v_xor_b32 v160, 96, v160
    s_waitcnt lgkmcnt(0)
    s_waitcnt vmcnt(2)
    s_barrier
    v_mfma_f32_32x32x16_bf16 v[128:143], v[144:147], v[96:99], v[128:143]
    ds_read_b64_tr_b16 v[144:145], v161 offset:28672
    ds_read_b64_tr_b16 v[146:147], v161 offset:28928
    ds_read_b128 v[112:115], v160 offset:28672
    v_xor_b32 v160, 32, v160
    s_add_u32 s53, s51, 2
    s_and_b32 s53, s53, 7
    s_mul_i32 s53, s53, 176128
    s_add_u32 m0, s56, 114688
    s_nop 0
    buffer_load_dwordx4 v164, s[12:15], s53 offen lds
    v_mfma_f32_32x32x16_bf16 v[128:143], v[148:151], v[100:103], v[128:143]
    ds_read_b64_tr_b16 v[148:149], v161 offset:29696
    ds_read_b64_tr_b16 v[150:151], v161 offset:29952
    ds_read_b128 v[116:119], v160 offset:28672
    v_xor_b32 v160, 96, v160
    s_add_u32 s53, s51, 3
    s_and_b32 s53, s53, 7
    s_mul_i32 s53, s53, 176128
    s_add_u32 m0, s56, 126976
    s_nop 0
    buffer_load_dwordx4 v164, s[12:15], s53 offen lds
    v_mfma_f32_32x32x16_bf16 v[128:143], v[152:155], v[104:107], v[128:143]
    ds_read_b64_tr_b16 v[152:153], v161 offset:30720
    ds_read_b64_tr_b16 v[154:155], v161 offset:30976
    ds_read_b128 v[120:123], v160 offset:28672
    v_xor_b32 v160, 32, v160
    v_mfma_f32_32x32x16_bf16 v[128:143], v[156:159], v[108:111], v[128:143]
    ds_read_b64_tr_b16 v[156:157], v161 offset:31744
    ds_read_b64_tr_b16 v[158:159], v161 offset:32000
    ds_read_b128 v[124:127], v160 offset:28672
    v_xor_b32 v160, 96, v160
    s_waitcnt lgkmcnt(9)
    v_mfma_f32_32x32x16_bf16 v[128:143], v[144:147], v[112:115], v[128:143]
    s_waitcnt lgkmcnt(6)
    v_mfma_f32_32x32x16_bf16 v[128:143], v[148:151], v[116:119], v[128:143]
    s_waitcnt lgkmcnt(3)
    v_mfma_f32_32x32x16_bf16 v[128:143], v[152:155], v[120:123], v[128:143]
    s_waitcnt lgkmcnt(0)
    v_mfma_f32_32x32x16_bf16 v[128:143], v[156:159], v[124:127], v[128:143]
    s_waitcnt vmcnt(2)
    s_barrier
    v_lshrrev_b32 v166, 5, v165
    v_lshlrev_b32 v166, 3, v166
    s_lshl_b32 s53, s55, 6
    s_add_u32 s53, s53, 162816
    v_add_u32 v166, s53, v166
    ds_read_b64 v[152:153], v166 offset:0
    ds_read_b64 v[154:155], v166 offset:16
    ds_read_b64 v[156:157], v166 offset:32
    ds_read_b64 v[158:159], v166 offset:48
    s_lshl_b32 s53, s52, 10
    s_add_u32 s53, s53, 153600
    v_lshl_add_u32 v160, v165, 4, s53
    s_mov_b32 s53, 1052289595
    s_nop 1
    v_mul_f32 v128, s53, v128
    v_mul_f32 v129, s53, v129
    v_mul_f32 v130, s53, v130
    v_mul_f32 v131, s53, v131
    v_mul_f32 v132, s53, v132
    v_mul_f32 v133, s53, v133
    v_mul_f32 v134, s53, v134
    v_mul_f32 v135, s53, v135
    v_mul_f32 v136, s53, v136
    v_mul_f32 v137, s53, v137
    v_mul_f32 v138, s53, v138
    v_mul_f32 v139, s53, v139
    v_mul_f32 v140, s53, v140
    v_mul_f32 v141, s53, v141
    v_mul_f32 v142, s53, v142
    v_mul_f32 v143, s53, v143
    v_cvt_pk_bf16_f32 v144, v128, v129
    v_cvt_pk_bf16_f32 v145, v130, v131
    v_cvt_pk_bf16_f32 v146, v132, v133
    v_cvt_pk_bf16_f32 v147, v134, v135
    v_cvt_pk_bf16_f32 v148, v136, v137
    v_cvt_pk_bf16_f32 v149, v138, v139
    v_cvt_pk_bf16_f32 v150, v140, v141
    v_cvt_pk_bf16_f32 v151, v142, v143
    ds_write_b128 v160, v[144:147]
    ds_write_b128 v160, v[148:151] offset:4096
    s_movk_i32 s53, 128
    v_lshrrev_b32 v166, 5, v165
    v_bfe_u32 v167, v165, 2, 2
    v_lshl_add_u32 v166, v166, 3, v167
    v_mul_u32_u24 v166, 192, v166
    v_add_u32 v166, s53, v166
    v_bfe_u32 v167, v165, 4, 1
    v_lshl_add_u32 v166, v167, 5, v166
    v_and_b32 v167, 3, v165
    v_lshl_add_u32 v161, v167, 3, v166
    s_waitcnt lgkmcnt(0)
    v_lshlrev_b32 v128, 16, v152
    v_and_b32 v129, 0xffff0000, v152
    v_lshlrev_b32 v130, 16, v153
    v_and_b32 v131, 0xffff0000, v153
    v_lshlrev_b32 v132, 16, v154
    v_and_b32 v133, 0xffff0000, v154
    v_lshlrev_b32 v134, 16, v155
    v_and_b32 v135, 0xffff0000, v155
    v_lshlrev_b32 v136, 16, v156
    v_and_b32 v137, 0xffff0000, v156
    v_lshlrev_b32 v138, 16, v157
    v_and_b32 v139, 0xffff0000, v157
    v_lshlrev_b32 v140, 16, v158
    v_and_b32 v141, 0xffff0000, v158
    v_lshlrev_b32 v142, 16, v159
    v_and_b32 v143, 0xffff0000, v159
    s_waitcnt vmcnt(2)
    v_add_u32 v161, 86016, v161
    ds_read_b64_tr_b16 v[144:145], v161 offset:0
    ds_read_b64_tr_b16 v[146:147], v161 offset:768
    ds_read_b64_tr_b16 v[148:149], v161 offset:3072
    ds_read_b64_tr_b16 v[150:151], v161 offset:3840
    ds_read_b64_tr_b16 v[152:153], v161 offset:6144
    ds_read_b64_tr_b16 v[154:155], v161 offset:6912
    ds_read_b64_tr_b16 v[156:157], v161 offset:9216
    ds_read_b64_tr_b16 v[158:159], v161 offset:9984
    s_waitcnt lgkmcnt(6)
    v_mfma_f32_32x32x16_bf16 v[128:143], v[144:147], v[0:3], v[128:143]
    ds_read_b64_tr_b16 v[144:145], v161 offset:12288
    ds_read_b64_tr_b16 v[146:147], v161 offset:13056
    s_add_u32 s53, s51, 4
    s_and_b32 s53, s53, 7
    s_mul_i32 s53, s53, 176128
    s_add_u32 m0, s56, 57344
    s_nop 0
    buffer_load_dwordx4 v164, s[12:15], s53 offen lds
    s_waitcnt lgkmcnt(6)
    v_mfma_f32_32x32x16_bf16 v[128:143], v[148:151], v[4:7], v[128:143]
    ds_read_b64_tr_b16 v[148:149], v161 offset:15360
    ds_read_b64_tr_b16 v[150:151], v161 offset:16128
    s_add_u32 s53, s51, 5
    s_and_b32 s53, s53, 7
    s_mul_i32 s53, s53, 176128
    s_add_u32 m0, s56, 69632
    s_nop 0
    buffer_load_dwordx4 v164, s[12:15], s53 offen lds
    s_waitcnt lgkmcnt(6)
    v_mfma_f32_32x32x16_bf16 v[128:143], v[152:155], v[8:11], v[128:143]
    ds_read_b64_tr_b16 v[152:153], v161 offset:18432
    ds_read_b64_tr_b16 v[154:155], v161 offset:19200
    s_add_u32 s53, s51, 6
    s_and_b32 s53, s53, 7
    s_mul_i32 s53, s53, 176128
    s_add_u32 m0, s56, 0
    s_nop 0
    buffer_load_dwordx4 v164, s[12:15], s53 offen lds
    s_waitcnt lgkmcnt(6)
    v_mfma_f32_32x32x16_bf16 v[128:143], v[156:159], v[12:15], v[128:143]
    ds_read_b64_tr_b16 v[156:157], v161 offset:21504
    ds_read_b64_tr_b16 v[158:159], v161 offset:22272
    s_add_u32 s53, s51, 7
    s_and_b32 s53, s53, 7
    s_mul_i32 s53, s53, 176128
    s_add_u32 m0, s56, 12288
    s_nop 0
    buffer_load_dwordx4 v164, s[12:15], s53 offen lds
    s_waitcnt lgkmcnt(6)
    v_mfma_f32_32x32x16_bf16 v[128:143], v[144:147], v[16:19], v[128:143]
    s_waitcnt lgkmcnt(4)
    v_mfma_f32_32x32x16_bf16 v[128:143], v[148:151], v[20:23], v[128:143]
    s_waitcnt lgkmcnt(2)
    v_mfma_f32_32x32x16_bf16 v[128:143], v[152:155], v[24:27], v[128:143]
    s_waitcnt lgkmcnt(0)
    v_mfma_f32_32x32x16_bf16 v[128:143], v[156:159], v[28:31], v[128:143]
    s_waitcnt vmcnt(4)
    s_barrier
    ds_read_b64_tr_b16 v[144:145], v161 offset:28672
    ds_read_b64_tr_b16 v[146:147], v161 offset:29440
    ds_read_b64_tr_b16 v[148:149], v161 offset:31744
    ds_read_b64_tr_b16 v[150:151], v161 offset:32512
    ds_read_b64_tr_b16 v[152:153], v161 offset:34816
    ds_read_b64_tr_b16 v[154:155], v161 offset:35584
    ds_read_b64_tr_b16 v[156:157], v161 offset:37888
    ds_read_b64_tr_b16 v[158:159], v161 offset:38656
    s_waitcnt lgkmcnt(6)
    v_mfma_f32_32x32x16_bf16 v[128:143], v[144:147], v[32:35], v[128:143]
    ds_read_b64_tr_b16 v[144:145], v161 offset:40960
    ds_read_b64_tr_b16 v[146:147], v161 offset:41728
    s_waitcnt lgkmcnt(6)
    v_mfma_f32_32x32x16_bf16 v[128:143], v[148:151], v[36:39], v[128:143]
    ds_read_b64_tr_b16 v[148:149], v161 offset:44032
    ds_read_b64_tr_b16 v[150:151], v161 offset:44800
    s_waitcnt lgkmcnt(6)
    v_mfma_f32_32x32x16_bf16 v[128:143], v[152:155], v[40:43], v[128:143]
    ds_read_b64_tr_b16 v[152:153], v161 offset:47104
    ds_read_b64_tr_b16 v[154:155], v161 offset:47872
    s_waitcnt lgkmcnt(6)
    v_mfma_f32_32x32x16_bf16 v[128:143], v[156:159], v[44:47], v[128:143]
    ds_read_b64_tr_b16 v[156:157], v161 offset:50176
    ds_read_b64_tr_b16 v[158:159], v161 offset:50944
    s_waitcnt lgkmcnt(6)
    v_mfma_f32_32x32x16_bf16 v[128:143], v[144:147], v[48:51], v[128:143]
    s_waitcnt lgkmcnt(4)
    v_mfma_f32_32x32x16_bf16 v[128:143], v[148:151], v[52:55], v[128:143]
    s_waitcnt lgkmcnt(2)
    v_mfma_f32_32x32x16_bf16 v[128:143], v[152:155], v[56:59], v[128:143]
    s_waitcnt lgkmcnt(0)
    v_mfma_f32_32x32x16_bf16 v[128:143], v[156:159], v[60:63], v[128:143]
    s_waitcnt vmcnt(0)
    s_barrier
    v_add_u32 v161, 4294938624, v161
    ds_read_b64_tr_b16 v[144:145], v161 offset:0
    ds_read_b64_tr_b16 v[146:147], v161 offset:768
    ds_read_b64_tr_b16 v[148:149], v161 offset:3072
    ds_read_b64_tr_b16 v[150:151], v161 offset:3840
    ds_read_b64_tr_b16 v[152:153], v161 offset:6144
    ds_read_b64_tr_b16 v[154:155], v161 offset:6912
    ds_read_b64_tr_b16 v[156:157], v161 offset:9216
    ds_read_b64_tr_b16 v[158:159], v161 offset:9984
    s_waitcnt lgkmcnt(6)
    v_mfma_f32_32x32x16_bf16 v[128:143], v[144:147], v[64:67], v[128:143]
    ds_read_b64_tr_b16 v[144:145], v161 offset:12288
    ds_read_b64_tr_b16 v[146:147], v161 offset:13056
    s_waitcnt lgkmcnt(6)
    v_mfma_f32_32x32x16_bf16 v[128:143], v[148:151], v[68:71], v[128:143]
    ds_read_b64_tr_b16 v[148:149], v161 offset:15360
    ds_read_b64_tr_b16 v[150:151], v161 offset:16128
    s_waitcnt lgkmcnt(6)
    v_mfma_f32_32x32x16_bf16 v[128:143], v[152:155], v[72:75], v[128:143]
    ds_read_b64_tr_b16 v[152:153], v161 offset:18432
    ds_read_b64_tr_b16 v[154:155], v161 offset:19200
    s_waitcnt lgkmcnt(6)
    v_mfma_f32_32x32x16_bf16 v[128:143], v[156:159], v[76:79], v[128:143]
    ds_read_b64_tr_b16 v[156:157], v161 offset:21504
    ds_read_b64_tr_b16 v[158:159], v161 offset:22272
    s_waitcnt lgkmcnt(6)
    v_mfma_f32_32x32x16_bf16 v[128:143], v[144:147], v[80:83], v[128:143]
    s_waitcnt lgkmcnt(4)
    v_mfma_f32_32x32x16_bf16 v[128:143], v[148:151], v[84:87], v[128:143]
    s_waitcnt lgkmcnt(2)
    v_mfma_f32_32x32x16_bf16 v[128:143], v[152:155], v[88:91], v[128:143]
    s_waitcnt lgkmcnt(0)
    v_mfma_f32_32x32x16_bf16 v[128:143], v[156:159], v[92:95], v[128:143]
    v_add_u32 v161, 4294909952, v161
    ds_read_b64_tr_b16 v[144:145], v161 offset:0
    ds_read_b64_tr_b16 v[146:147], v161 offset:768
    ds_read_b64_tr_b16 v[148:149], v161 offset:3072
    ds_read_b64_tr_b16 v[150:151], v161 offset:3840
    ds_read_b64_tr_b16 v[152:153], v161 offset:6144
    ds_read_b64_tr_b16 v[154:155], v161 offset:6912
    ds_read_b64_tr_b16 v[156:157], v161 offset:9216
    ds_read_b64_tr_b16 v[158:159], v161 offset:9984
    s_waitcnt lgkmcnt(6)
    v_mfma_f32_32x32x16_bf16 v[128:143], v[144:147], v[96:99], v[128:143]
    ds_read_b64_tr_b16 v[144:145], v161 offset:12288
    ds_read_b64_tr_b16 v[146:147], v161 offset:13056
    s_waitcnt lgkmcnt(6)
    v_mfma_f32_32x32x16_bf16 v[128:143], v[148:151], v[100:103], v[128:143]
    ds_read_b64_tr_b16 v[148:149], v161 offset:15360
    ds_read_b64_tr_b16 v[150:151], v161 offset:16128
    s_waitcnt lgkmcnt(6)
    v_mfma_f32_32x32x16_bf16 v[128:143], v[152:155], v[104:107], v[128:143]
    ds_read_b64_tr_b16 v[152:153], v161 offset:18432
    ds_read_b64_tr_b16 v[154:155], v161 offset:19200
    s_waitcnt lgkmcnt(6)
    v_mfma_f32_32x32x16_bf16 v[128:143], v[156:159], v[108:111], v[128:143]
    ds_read_b64_tr_b16 v[156:157], v161 offset:21504
    ds_read_b64_tr_b16 v[158:159], v161 offset:22272
    s_waitcnt lgkmcnt(6)
    v_mfma_f32_32x32x16_bf16 v[128:143], v[144:147], v[112:115], v[128:143]
    s_waitcnt lgkmcnt(4)
    v_mfma_f32_32x32x16_bf16 v[128:143], v[148:151], v[116:119], v[128:143]
    s_waitcnt lgkmcnt(2)
    v_mfma_f32_32x32x16_bf16 v[128:143], v[152:155], v[120:123], v[128:143]
    s_waitcnt lgkmcnt(0)
    v_mfma_f32_32x32x16_bf16 v[128:143], v[156:159], v[124:127], v[128:143]
    s_cmp_lg_u32 s48, 8
    s_cbranch_scc1 L_e0
    s_lshr_b32 s56, s49, 1
    s_lshl_b32 s56, s56, 8
    v_mov_b32 v164, 0
    s_mov_b64 exec, 1
    buffer_load_dword v163, v164, s[44:47], s56 offen sc1
    s_mov_b64 exec, -1
L_e0:
    v_lshrrev_b32 v166, 3, v165
    v_lshlrev_b32 v166, 10, v166
    v_bfe_u32 v167, v165, 4, 1
    v_lshlrev_b32 v167, 2, v167
    v_and_b32 v161, 7, v165
    v_xor_b32 v161, v161, v167
    v_lshl_add_u32 v161, v161, 4, v166
    s_lshr_b32 s53, s49, 1
    s_lshl_b32 s53, s53, 7
    v_add_u32 v161, s53, v161
    v_add_u32 v162, 8192, v161
    s_nop 0
    v_max_f32 v128, 0, v128
    v_max_f32 v129, 0, v129
    v_max_f32 v130, 0, v130
    v_max_f32 v131, 0, v131
    v_max_f32 v132, 0, v132
    v_max_f32 v133, 0, v133
    v_max_f32 v134, 0, v134
    v_max_f32 v135, 0, v135
    v_max_f32 v136, 0, v136
    v_max_f32 v137, 0, v137
    v_max_f32 v138, 0, v138
    v_max_f32 v139, 0, v139
    v_max_f32 v140, 0, v140
    v_max_f32 v141, 0, v141
    v_max_f32 v142, 0, v142
    v_max_f32 v143, 0, v143
    v_pk_mul_f32 v[128:129], v[128:129], v[128:129]
    v_pk_mul_f32 v[130:131], v[130:131], v[130:131]
    v_pk_mul_f32 v[132:133], v[132:133], v[132:133]
    v_pk_mul_f32 v[134:135], v[134:135], v[134:135]
    v_pk_mul_f32 v[136:137], v[136:137], v[136:137]
    v_pk_mul_f32 v[138:139], v[138:139], v[138:139]
    v_pk_mul_f32 v[140:141], v[140:141], v[140:141]
    v_pk_mul_f32 v[142:143], v[142:143], v[142:143]
    v_cvt_pk_bf16_f32 v144, v128, v129
    v_cvt_pk_bf16_f32 v145, v130, v131
    v_cvt_pk_bf16_f32 v146, v132, v133
    v_cvt_pk_bf16_f32 v147, v134, v135
    v_cvt_pk_bf16_f32 v148, v136, v137
    v_cvt_pk_bf16_f32 v149, v138, v139
    v_cvt_pk_bf16_f32 v150, v140, v141
    v_cvt_pk_bf16_f32 v151, v142, v143
    s_cmp_lg_u32 s48, 8
    s_cbranch_scc1 L_e
    s_mov_b64 exec, 1
    s_waitcnt vmcnt(0)
    v_cmp_eq_u32 vcc, 32, v163
    s_mov_b64 exec, -1
    s_cbranch_vccnz L_e
    v_mov_b32 v167, 0
    s_mov_b64 exec, 1
L_poll_2:
    buffer_load_dword v166, v167, s[44:47], s56 offen sc1
    s_waitcnt vmcnt(0)
    v_cmp_eq_u32 vcc, 32, v166
    s_nop 0
    s_cbranch_vccnz L_polld_3
    s_sleep 1
    s_branch L_poll_2
L_polld_3:
    s_mov_b64 exec, -1
L_e:
    s_barrier
    s_setprio 3
    s_mul_i32 s53, s49, 3
    s_add_u32 s53, s53, s55
    s_cmp_ge_u32 s53, 43
    s_cbranch_scc1 L_hs_4
    s_lshl_b32 s53, s53, 1
    s_lshl_b32 s54, s50, 2
    s_add_u32 s54, s54, s52
    s_mul_i32 s54, s54, 86
    s_add_u32 s53, s53, s54
    s_lshl_b32 s53, s53, 10
    s_add_u32 s53, s53, 8388608
    v_lshlrev_b32 v166, 4, v165
    buffer_store_dwordx4 v[144:147], v166, s[44:47], s53 offen sc1
    buffer_store_dwordx4 v[148:151], v166, s[44:47], s53 offen offset:1024 sc1
L_hs_4:
    v_lshrrev_b32 v166, 5, v165
    v_lshlrev_b32 v166, 4, v166
    v_add_u32 v166, 161792, v166
    ds_read_b128 v[152:155], v166 offset:0
    ds_read_b128 v[156:159], v166 offset:32
    ds_read_b128 v[144:147], v166 offset:64
    ds_read_b128 v[148:151], v166 offset:96
    s_waitcnt lgkmcnt(3)
    v_mfma_f32_32x32x16_bf16 v[128:143], v[152:155], v[0:3], 0
    ds_read_b128 v[152:155], v166 offset:128
    s_waitcnt lgkmcnt(3)
    v_mfma_f32_32x32x16_bf16 v[128:143], v[156:159], v[4:7], v[128:143]
    ds_read_b128 v[156:159], v166 offset:160
    s_waitcnt lgkmcnt(3)
    v_mfma_f32_32x32x16_bf16 v[128:143], v[144:147], v[8:11], v[128:143]
    ds_read_b128 v[144:147], v166 offset:192
    s_waitcnt lgkmcnt(3)
    v_mfma_f32_32x32x16_bf16 v[128:143], v[148:151], v[12:15], v[128:143]
    ds_read_b128 v[148:151], v166 offset:224
    s_waitcnt lgkmcnt(3)
    v_mfma_f32_32x32x16_bf16 v[128:143], v[152:155], v[16:19], v[128:143]
    ds_read_b128 v[152:155], v166 offset:256
    s_waitcnt lgkmcnt(3)
    v_mfma_f32_32x32x16_bf16 v[128:143], v[156:159], v[20:23], v[128:143]
    ds_read_b128 v[156:159], v166 offset:288
    s_waitcnt lgkmcnt(3)
    v_mfma_f32_32x32x16_bf16 v[128:143], v[144:147], v[24:27], v[128:143]
    ds_read_b128 v[144:147], v166 offset:320
    s_waitcnt lgkmcnt(3)
    v_mfma_f32_32x32x16_bf16 v[128:143], v[148:151], v[28:31], v[128:143]
    ds_read_b128 v[148:151], v166 offset:352
    s_waitcnt lgkmcnt(3)
    v_mfma_f32_32x32x16_bf16 v[128:143], v[152:155], v[32:35], v[128:143]
    ds_read_b128 v[152:155], v166 offset:384
    s_waitcnt lgkmcnt(3)
    v_mfma_f32_32x32x16_bf16 v[128:143], v[156:159], v[36:39], v[128:143]
    ds_read_b128 v[156:159], v166 offset:416
    s_waitcnt lgkmcnt(3)
    v_mfma_f32_32x32x16_bf16 v[128:143], v[144:147], v[40:43], v[128:143]
    ds_read_b128 v[144:147], v166 offset:448
    s_waitcnt lgkmcnt(3)
    v_mfma_f32_32x32x16_bf16 v[128:143], v[148:151], v[44:47], v[128:143]
    ds_read_b128 v[148:151], v166 offset:480
    s_waitcnt lgkmcnt(3)
    v_mfma_f32_32x32x16_bf16 v[128:143], v[152:155], v[48:51], v[128:143]
    ds_read_b128 v[152:155], v166 offset:512
    s_waitcnt lgkmcnt(3)
    v_mfma_f32_32x32x16_bf16 v[128:143], v[156:159], v[52:55], v[128:143]
    ds_read_b128 v[156:159], v166 offset:544
    s_waitcnt lgkmcnt(3)
    v_mfma_f32_32x32x16_bf16 v[128:143], v[144:147], v[56:59], v[128:143]
    ds_read_b128 v[144:147], v166 offset:576
    s_waitcnt lgkmcnt(3)
    v_mfma_f32_32x32x16_bf16 v[128:143], v[148:151], v[60:63], v[128:143]
    ds_read_b128 v[148:151], v166 offset:608
    s_waitcnt lgkmcnt(3)
    v_mfma_f32_32x32x16_bf16 v[128:143], v[152:155], v[64:67], v[128:143]
    ds_read_b128 v[152:155], v166 offset:640
    s_waitcnt lgkmcnt(3)
    v_mfma_f32_32x32x16_bf16 v[128:143], v[156:159], v[68:71], v[128:143]
    ds_read_b128 v[156:159], v166 offset:672
    s_waitcnt lgkmcnt(3)
    v_mfma_f32_32x32x16_bf16 v[128:143], v[144:147], v[72:75], v[128:143]
    ds_read_b128 v[144:147], v166 offset:704
    s_waitcnt lgkmcnt(3)
    v_mfma_f32_32x32x16_bf16 v[128:143], v[148:151], v[76:79], v[128:143]
    ds_read_b128 v[148:151], v166 offset:736
    s_waitcnt lgkmcnt(3)
    v_mfma_f32_32x32x16_bf16 v[128:143], v[152:155], v[80:83], v[128:143]
    ds_read_b128 v[152:155], v166 offset:768
    s_waitcnt lgkmcnt(3)
    v_mfma_f32_32x32x16_bf16 v[128:143], v[156:159], v[84:87], v[128:143]
    ds_read_b128 v[156:159], v166 offset:800
    s_waitcnt lgkmcnt(3)
    v_mfma_f32_32x32x16_bf16 v[128:143], v[144:147], v[88:91], v[128:143]
    ds_read_b128 v[144:147], v166 offset:832
    s_waitcnt lgkmcnt(3)
    v_mfma_f32_32x32x16_bf16 v[128:143], v[148:151], v[92:95], v[128:143]
    ds_read_b128 v[148:151], v166 offset:864
    s_waitcnt lgkmcnt(3)
    v_mfma_f32_32x32x16_bf16 v[128:143], v[152:155], v[96:99], v[128:143]
    ds_read_b128 v[152:155], v166 offset:896
    s_waitcnt lgkmcnt(3)
    v_mfma_f32_32x32x16_bf16 v[128:143], v[156:159], v[100:103], v[128:143]
    ds_read_b128 v[156:159], v166 offset:928
    s_waitcnt lgkmcnt(3)
    v_mfma_f32_32x32x16_bf16 v[128:143], v[144:147], v[104:107], v[128:143]
    ds_read_b128 v[144:147], v166 offset:960
    s_waitcnt lgkmcnt(3)
    v_mfma_f32_32x32x16_bf16 v[128:143], v[148:151], v[108:111], v[128:143]
    ds_read_b128 v[148:151], v166 offset:992
    s_waitcnt lgkmcnt(3)
    v_mfma_f32_32x32x16_bf16 v[128:143], v[152:155], v[112:115], v[128:143]
    s_waitcnt lgkmcnt(2)
    v_mfma_f32_32x32x16_bf16 v[128:143], v[156:159], v[116:119], v[128:143]
    s_waitcnt lgkmcnt(1)
    v_mfma_f32_32x32x16_bf16 v[128:143], v[144:147], v[120:123], v[128:143]
    s_waitcnt lgkmcnt(0)
    v_mfma_f32_32x32x16_bf16 v[128:143], v[148:151], v[124:127], v[128:143]
    s_nop 7
    s_nop 3
    v_mul_f32 v128, 0xbfb8aa3b, v128
    v_exp_f32 v128, v128
    v_and_b32 v166, 31, v165
    v_add_f32 v128, 1.0, v128
    v_rcp_f32 v128, v128
    s_lshl_b32 s53, s52, 7
    s_add_u32 s53, s53, 163072
    v_lshl_add_u32 v166, v166, 2, s53
    ds_write_b32 v166, v128
    s_lshl_b32 s53, s48, 2
    s_add_u32 s53, s53, 163584
    v_mov_b32 v166, s53
    v_mov_b32 v167, 1
    s_waitcnt vmcnt(0)
    ds_write_b32 v166, v167
    v_lshrrev_b32 v166, 5, v165
    v_bfe_u32 v167, v165, 2, 2
    v_lshl_add_u32 v166, v166, 2, v167
    v_lshlrev_b32 v166, 7, v166
    v_bfe_u32 v167, v165, 4, 1
    v_lshl_add_u32 v166, v167, 5, v166
    v_and_b32 v167, 3, v165
    v_lshl_add_u32 v166, v167, 3, v166
    v_bfe_u32 v167, v165, 3, 1
    v_lshl_add_u32 v166, v167, 6, v166
    s_lshl_b32 s59, s52, 13
    s_add_u32 s59, s59, 120832
    v_add_u32 v163, s59, v166
    v_xor_b32 v164, 64, v163
    v_mov_b64 v[0:1], 0
    v_mov_b64 v[2:3], 0
    v_mov_b64 v[4:5], 0
    v_mov_b64 v[6:7], 0
    v_mov_b64 v[8:9], 0
    v_mov_b64 v[10:11], 0
    v_mov_b64 v[12:13], 0
    v_mov_b64 v[14:15], 0
    v_mov_b64 v[16:17], 0
    v_mov_b64 v[18:19], 0
    v_mov_b64 v[20:21], 0
    v_mov_b64 v[22:23], 0
    v_mov_b64 v[24:25], 0
    v_mov_b64 v[26:27], 0
    v_mov_b64 v[28:29], 0
    v_mov_b64 v[30:31], 0
    v_mov_b64 v[32:33], 0
    v_mov_b64 v[34:35], 0
    v_mov_b64 v[36:37], 0
    v_mov_b64 v[38:39], 0
    v_mov_b64 v[40:41], 0
    v_mov_b64 v[42:43], 0
    v_mov_b64 v[44:45], 0
    v_mov_b64 v[46:47], 0
    v_mov_b64 v[48:49], 0
    v_mov_b64 v[50:51], 0
    v_mov_b64 v[52:53], 0
    v_mov_b64 v[54:55], 0
    v_mov_b64 v[56:57], 0
    v_mov_b64 v[58:59], 0
    v_mov_b64 v[60:61], 0
    v_mov_b64 v[62:63], 0
    s_mul_i32 s56, s52, 22
    s_cmp_eq_u32 s52, 3
    s_subb_u32 s56, s56, 0
    s_lshr_b32 s53, s52, 1
    s_sub_u32 s62, 22, s53
    s_add_u32 s57, s56, s62
    s_sub_u32 s57, s57, 1
    s_lshl_b32 s53, s50, 2
    s_and_b32 s54, s49, 1
    s_lshl_b32 s54, s54, 1
    s_add_u32 s58, s53, s54
    s_mul_i32 s53, s58, 88064
    s_add_u32 s53, s53, 8388608
    v_lshl_add_u32 v160, v165, 4, s53
    s_lshl_b32 s55, s50, 8
    s_add_u32 s55, s55, 4096
    s_cmp_lg_u32 s48, 8
    s_cbranch_scc1 L_s2done
    v_lshlrev_b32 v166, 2, v165
    v_add_u32 v166, 163584, v166
    s_mov_b64 exec, 0xfff
L_flg:
    ds_read_b32 v167, v166
    s_waitcnt lgkmcnt(0)
    v_cmp_ne_u32 vcc, 1, v167
    s_nop 0
    s_cbranch_vccz L_flgok
    s_sleep 4
    s_branch L_flg
L_flgok:
    s_mov_b64 exec, -1
    v_mov_b32 v166, 0
    v_mov_b32 v167, 1
    s_mov_b64 exec, 1
    buffer_atomic_add v167, v166, s[44:47], s55 offen sc1
    s_mov_b64 exec, -1
L_s2done:
    s_setprio 1
    s_lshl_b32 s53, s52, 17
    s_lshl_b32 s54, s52, 14
    s_add_u32 s54, s54, 55296
    s_add_u32 m0, s54, 0
    s_nop 0
    buffer_load_dwordx4 v161, s[20:23], s53 offen lds
    s_add_u32 m0, s54, 1024
    s_nop 0
    buffer_load_dwordx4 v162, s[20:23], s53 offen lds
    s_add_u32 s53, s53, 16384
    s_add_u32 m0, s54, 2048
    s_nop 0
    buffer_load_dwordx4 v161, s[20:23], s53 offen lds
    s_add_u32 m0, s54, 3072
    s_nop 0
    buffer_load_dwordx4 v162, s[20:23], s53 offen lds
    s_add_u32 s53, s53, 16384
    s_add_u32 m0, s54, 4096
    s_nop 0
    buffer_load_dwordx4 v161, s[20:23], s53 offen lds
    s_add_u32 m0, s54, 5120
    s_nop 0
    buffer_load_dwordx4 v162, s[20:23], s53 offen lds
    s_add_u32 s53, s53, 16384
    s_add_u32 m0, s54, 6144
    s_nop 0
    buffer_load_dwordx4 v161, s[20:23], s53 offen lds
    s_add_u32 m0, s54, 7168
    s_nop 0
    buffer_load_dwordx4 v162, s[20:23], s53 offen lds
    s_add_u32 s53, s53, 16384
    s_add_u32 m0, s54, 8192
    s_nop 0
    buffer_load_dwordx4 v161, s[20:23], s53 offen lds
    s_add_u32 m0, s54, 9216
    s_nop 0
    buffer_load_dwordx4 v162, s[20:23], s53 offen lds
    s_add_u32 s53, s53, 16384
    s_add_u32 m0, s54, 10240
    s_nop 0
    buffer_load_dwordx4 v161, s[20:23], s53 offen lds
    s_add_u32 m0, s54, 11264
    s_nop 0
    buffer_load_dwordx4 v162, s[20:23], s53 offen lds
    s_add_u32 s53, s53, 16384
    s_add_u32 m0, s54, 12288
    s_nop 0
    buffer_load_dwordx4 v161, s[20:23], s53 offen lds
    s_add_u32 m0, s54, 13312
    s_nop 0
    buffer_load_dwordx4 v162, s[20:23], s53 offen lds
    s_add_u32 s53, s53, 16384
    s_add_u32 m0, s54, 14336
    s_nop 0
    buffer_load_dwordx4 v161, s[20:23], s53 offen lds
    s_add_u32 m0, s54, 15360
    s_nop 0
    buffer_load_dwordx4 v162, s[20:23], s53 offen lds
    s_add_u32 s53, s53, 16384
    v_mov_b32 v167, 0
    s_mov_b64 exec, 1
L_poll_5:
    buffer_load_dword v166, v167, s[44:47], s55 offen sc1
    s_waitcnt vmcnt(0)
    v_cmp_eq_u32 vcc, 16, v166
    s_nop 0
    s_cbranch_vccnz L_polld_6
    s_sleep 1
    s_branch L_poll_5
L_polld_6:
    s_mov_b64 exec, -1
    s_lshl_b32 s53, s56, 14
    s_add_u32 m0, s59, 0
    s_lshl_b32 s54, s56, 10
    buffer_load_dwordx4 v161, s[16:19], s53 offen lds
    s_add_u32 m0, s59, 1024
    buffer_load_dwordx4 v[64:67], v160, s[44:47], s54 offen sc1
    buffer_load_dwordx4 v162, s[16:19], s53 offen lds
    s_add_u32 s54, s54, 88064
    s_add_u32 s56, s56, 1
    buffer_load_dwordx4 v[68:71], v160, s[44:47], s54 offen sc1
    s_min_u32 s56, s56, s57
    s_lshl_b32 s53, s56, 14
    s_add_u32 m0, s59, 2048
    s_lshl_b32 s54, s56, 10
    buffer_load_dwordx4 v161, s[16:19], s53 offen lds
    s_add_u32 m0, s59, 3072
    buffer_load_dwordx4 v[72:75], v160, s[44:47], s54 offen sc1
    buffer_load_dwordx4 v162, s[16:19], s53 offen lds
    s_add_u32 s54, s54, 88064
    s_add_u32 s56, s56, 1
    buffer_load_dwordx4 v[76:79], v160, s[44:47], s54 offen sc1
    s_min_u32 s56, s56, s57
    s_lshl_b32 s53, s56, 14
    s_add_u32 m0, s59, 4096
    s_lshl_b32 s54, s56, 10
    buffer_load_dwordx4 v161, s[16:19], s53 offen lds
    s_add_u32 m0, s59, 5120
    buffer_load_dwordx4 v[80:83], v160, s[44:47], s54 offen sc1
    buffer_load_dwordx4 v162, s[16:19], s53 offen lds
    s_add_u32 s54, s54, 88064
    s_add_u32 s56, s56, 1
    buffer_load_dwordx4 v[84:87], v160, s[44:47], s54 offen sc1
    s_min_u32 s56, s56, s57
    s_lshl_b32 s53, s56, 14
    s_add_u32 m0, s59, 6144
    s_lshl_b32 s54, s56, 10
    buffer_load_dwordx4 v161, s[16:19], s53 offen lds
    s_add_u32 m0, s59, 7168
    buffer_load_dwordx4 v[88:91], v160, s[44:47], s54 offen sc1
    buffer_load_dwordx4 v162, s[16:19], s53 offen lds
    s_add_u32 s54, s54, 88064
    s_add_u32 s56, s56, 1
    buffer_load_dwordx4 v[92:95], v160, s[44:47], s54 offen sc1
    s_min_u32 s56, s56, s57
L_f2:
    s_waitcnt vmcnt(12)
    ds_read_b64_tr_b16 v[96:97], v163 offset:0
    ds_read_b64_tr_b16 v[98:99], v163 offset:1024
    s_waitcnt lgkmcnt(0)
    v_mfma_f32_32x32x16_bf16 v[0:15], v[96:99], v[64:67], v[0:15]
    ds_read_b64_tr_b16 v[100:101], v164 offset:0
    s_waitcnt lgkmcnt(0)
    v_mfma_f32_32x32x16_bf16 v[32:47], v[96:99], v[68:71], v[32:47]
    ds_read_b64_tr_b16 v[102:103], v164 offset:1024
    s_waitcnt lgkmcnt(0)
    v_mfma_f32_32x32x16_bf16 v[16:31], v[100:103], v[64:67], v[16:31]
    s_sub_u32 s62, s62, 1
    s_cmp_eq_u32 s62, 0
    s_cbranch_scc1 L_f2x0
    s_lshl_b32 s53, s56, 14
    s_add_u32 m0, s59, 0
    s_lshl_b32 s54, s56, 10
    buffer_load_dwordx4 v161, s[16:19], s53 offen lds
    s_add_u32 m0, s59, 1024
    buffer_load_dwordx4 v[64:67], v160, s[44:47], s54 offen sc1
    buffer_load_dwordx4 v162, s[16:19], s53 offen lds
    v_mfma_f32_32x32x16_bf16 v[48:63], v[100:103], v[68:71], v[48:63]
    s_add_u32 s54, s54, 88064
    s_add_u32 s56, s56, 1
    buffer_load_dwordx4 v[68:71], v160, s[44:47], s54 offen sc1
    s_min_u32 s56, s56, s57
    s_waitcnt vmcnt(12)
    ds_read_b64_tr_b16 v[96:97], v163 offset:2048
    ds_read_b64_tr_b16 v[98:99], v163 offset:3072
    s_waitcnt lgkmcnt(0)
    v_mfma_f32_32x32x16_bf16 v[0:15], v[96:99], v[72:75], v[0:15]
    ds_read_b64_tr_b16 v[100:101], v164 offset:2048
    s_waitcnt lgkmcnt(0)
    v_mfma_f32_32x32x16_bf16 v[32:47], v[96:99], v[76:79], v[32:47]
    ds_read_b64_tr_b16 v[102:103], v164 offset:3072
    s_waitcnt lgkmcnt(0)
    v_mfma_f32_32x32x16_bf16 v[16:31], v[100:103], v[72:75], v[16:31]
    s_sub_u32 s62, s62, 1
    s_cmp_eq_u32 s62, 0
    s_cbranch_scc1 L_f2x1
    s_lshl_b32 s53, s56, 14
    s_add_u32 m0, s59, 2048
    s_lshl_b32 s54, s56, 10
    buffer_load_dwordx4 v161, s[16:19], s53 offen lds
    s_add_u32 m0, s59, 3072
    buffer_load_dwordx4 v[72:75], v160, s[44:47], s54 offen sc1
    buffer_load_dwordx4 v162, s[16:19], s53 offen lds
    v_mfma_f32_32x32x16_bf16 v[48:63], v[100:103], v[76:79], v[48:63]
    s_add_u32 s54, s54, 88064
    s_add_u32 s56, s56, 1
    buffer_load_dwordx4 v[76:79], v160, s[44:47], s54 offen sc1
    s_min_u32 s56, s56, s57
    s_waitcnt vmcnt(12)
    ds_read_b64_tr_b16 v[96:97], v163 offset:4096
    ds_read_b64_tr_b16 v[98:99], v163 offset:5120
    s_waitcnt lgkmcnt(0)
    v_mfma_f32_32x32x16_bf16 v[0:15], v[96:99], v[80:83], v[0:15]
    ds_read_b64_tr_b16 v[100:101], v164 offset:4096
    s_waitcnt lgkmcnt(0)
    v_mfma_f32_32x32x16_bf16 v[32:47], v[96:99], v[84:87], v[32:47]
    ds_read_b64_tr_b16 v[102:103], v164 offset:5120
    s_waitcnt lgkmcnt(0)
    v_mfma_f32_32x32x16_bf16 v[16:31], v[100:103], v[80:83], v[16:31]
    s_sub_u32 s62, s62, 1
    s_cmp_eq_u32 s62, 0
    s_cbranch_scc1 L_f2x2
    s_lshl_b32 s53, s56, 14
    s_add_u32 m0, s59, 4096
    s_lshl_b32 s54, s56, 10
    buffer_load_dwordx4 v161, s[16:19], s53 offen lds
    s_add_u32 m0, s59, 5120
    buffer_load_dwordx4 v[80:83], v160, s[44:47], s54 offen sc1
    buffer_load_dwordx4 v162, s[16:19], s53 offen lds
    v_mfma_f32_32x32x16_bf16 v[48:63], v[100:103], v[84:87], v[48:63]
    s_add_u32 s54, s54, 88064
    s_add_u32 s56, s56, 1
    buffer_load_dwordx4 v[84:87], v160, s[44:47], s54 offen sc1
    s_min_u32 s56, s56, s57
    s_waitcnt vmcnt(12)
    ds_read_b64_tr_b16 v[96:97], v163 offset:6144
    ds_read_b64_tr_b16 v[98:99], v163 offset:7168
    s_waitcnt lgkmcnt(0)
    v_mfma_f32_32x32x16_bf16 v[0:15], v[96:99], v[88:91], v[0:15]
    ds_read_b64_tr_b16 v[100:101], v164 offset:6144
    s_waitcnt lgkmcnt(0)
    v_mfma_f32_32x32x16_bf16 v[32:47], v[96:99], v[92:95], v[32:47]
    ds_read_b64_tr_b16 v[102:103], v164 offset:7168
    s_waitcnt lgkmcnt(0)
    v_mfma_f32_32x32x16_bf16 v[16:31], v[100:103], v[88:91], v[16:31]
    s_sub_u32 s62, s62, 1
    s_cmp_eq_u32 s62, 0
    s_cbranch_scc1 L_f2x3
    s_lshl_b32 s53, s56, 14
    s_add_u32 m0, s59, 6144
    s_lshl_b32 s54, s56, 10
    buffer_load_dwordx4 v161, s[16:19], s53 offen lds
    s_add_u32 m0, s59, 7168
    buffer_load_dwordx4 v[88:91], v160, s[44:47], s54 offen sc1
    buffer_load_dwordx4 v162, s[16:19], s53 offen lds
    v_mfma_f32_32x32x16_bf16 v[48:63], v[100:103], v[92:95], v[48:63]
    s_add_u32 s54, s54, 88064
    s_add_u32 s56, s56, 1
    buffer_load_dwordx4 v[92:95], v160, s[44:47], s54 offen sc1
    s_min_u32 s56, s56, s57
    s_branch L_f2
L_f2x0:
    v_mfma_f32_32x32x16_bf16 v[48:63], v[100:103], v[68:71], v[48:63]
    s_branch L_f2done
L_f2x1:
    v_mfma_f32_32x32x16_bf16 v[48:63], v[100:103], v[76:79], v[48:63]
    s_branch L_f2done
L_f2x2:
    v_mfma_f32_32x32x16_bf16 v[48:63], v[100:103], v[84:87], v[48:63]
    s_branch L_f2done
L_f2x3:
    v_mfma_f32_32x32x16_bf16 v[48:63], v[100:103], v[92:95], v[48:63]
L_f2done:
    s_lshl_b32 s53, s52, 14
    s_add_u32 s53, s53, 55296
    s_sub_u32 s53, s53, s59
    v_add_u32 v163, s53, v163
    v_add_u32 v164, s53, v164
    s_lshl_b32 s53, s58, 15
    s_lshl_b32 s54, s52, 13
    s_add_u32 s53, s53, s54
    s_add_u32 s53, s53, 16777216
    s_waitcnt vmcnt(0)
    v_lshl_add_u32 v160, v165, 4, s53
    v_and_b32 v65, 7, v165
    v_lshl_add_u32 v65, v65, 10, s53
    v_bfe_u32 v166, v165, 3, 1
    v_lshl_add_u32 v65, v166, 15, v65
    v_and_b32 v166, 31, v165
    s_and_b32 s54, s49, 1
    s_lshl_b32 s54, s54, 8
    s_add_u32 s54, s54, 163072
    v_lshl_add_u32 v162, v166, 2, s54
    v_lshrrev_b32 v167, 5, v165
    v_and_b32 v161, 15, v165
    v_xor_b32 v161, v161, v167
    v_lshlrev_b32 v161, 4, v161
    v_lshl_add_u32 v161, v166, 8, v161
    s_lshl_b32 s53, s52, 14
    s_add_u32 s53, s53, 55296
    v_add_u32 v161, s53, v161
    s_waitcnt vmcnt(0)
    ds_read_b64_tr_b16 v[128:129], v163 offset:0
    ds_read_b64_tr_b16 v[130:131], v163 offset:1024
    ds_read_b64_tr_b16 v[132:133], v164 offset:0
    ds_read_b64_tr_b16 v[134:135], v164 offset:1024
    ds_read_b64_tr_b16 v[136:137], v163 offset:2048
    ds_read_b64_tr_b16 v[138:139], v163 offset:3072
    ds_read_b64_tr_b16 v[140:141], v164 offset:2048
    ds_read_b64_tr_b16 v[142:143], v164 offset:3072
    ds_read_b64_tr_b16 v[144:145], v163 offset:4096
    ds_read_b64_tr_b16 v[146:147], v163 offset:5120
    ds_read_b64_tr_b16 v[148:149], v164 offset:4096
    ds_read_b64_tr_b16 v[150:151], v164 offset:5120
    ds_read_b64_tr_b16 v[152:153], v163 offset:6144
    ds_read_b64_tr_b16 v[154:155], v163 offset:7168
    ds_read_b64_tr_b16 v[156:157], v164 offset:6144
    ds_read_b64_tr_b16 v[158:159], v164 offset:7168
    s_mov_b32 s54, 4096
    s_mov_b32 s55, 32768
    s_mov_b32 s56, 36864
    s_mov_b32 s57, 0
    s_barrier
    s_setprio 0
    s_mov_b64 exec, 0xffff
    buffer_load_dword v64, v65, s[44:47], 0 offen sc1
    s_mov_b64 exec, -1
    ds_read_b32 v166, v162
    ds_read_b32 v162, v162 offset:128
    s_waitcnt lgkmcnt(0)
    v_sub_f32 v166, 1.0, v166
    v_sub_f32 v162, 1.0, v162
    v_pk_mul_f32 v[0:1], v[0:1], v[166:167] op_sel_hi:[1,0]
    v_pk_mul_f32 v[2:3], v[2:3], v[166:167] op_sel_hi:[1,0]
    v_pk_mul_f32 v[4:5], v[4:5], v[166:167] op_sel_hi:[1,0]
    v_pk_mul_f32 v[6:7], v[6:7], v[166:167] op_sel_hi:[1,0]
    v_pk_mul_f32 v[8:9], v[8:9], v[166:167] op_sel_hi:[1,0]
    v_pk_mul_f32 v[10:11], v[10:11], v[166:167] op_sel_hi:[1,0]
    v_pk_mul_f32 v[12:13], v[12:13], v[166:167] op_sel_hi:[1,0]
    v_pk_mul_f32 v[14:15], v[14:15], v[166:167] op_sel_hi:[1,0]
    v_pk_mul_f32 v[16:17], v[16:17], v[166:167] op_sel_hi:[1,0]
    v_pk_mul_f32 v[18:19], v[18:19], v[166:167] op_sel_hi:[1,0]
    v_pk_mul_f32 v[20:21], v[20:21], v[166:167] op_sel_hi:[1,0]
    v_pk_mul_f32 v[22:23], v[22:23], v[166:167] op_sel_hi:[1,0]
    v_pk_mul_f32 v[24:25], v[24:25], v[166:167] op_sel_hi:[1,0]
    v_pk_mul_f32 v[26:27], v[26:27], v[166:167] op_sel_hi:[1,0]
    v_pk_mul_f32 v[28:29], v[28:29], v[166:167] op_sel_hi:[1,0]
    v_pk_mul_f32 v[30:31], v[30:31], v[166:167] op_sel_hi:[1,0]
    v_pk_mul_f32 v[32:33], v[32:33], v[162:163] op_sel_hi:[1,0]
    v_pk_mul_f32 v[34:35], v[34:35], v[162:163] op_sel_hi:[1,0]
    v_pk_mul_f32 v[36:37], v[36:37], v[162:163] op_sel_hi:[1,0]
    v_pk_mul_f32 v[38:39], v[38:39], v[162:163] op_sel_hi:[1,0]
    v_pk_mul_f32 v[40:41], v[40:41], v[162:163] op_sel_hi:[1,0]
    v_pk_mul_f32 v[42:43], v[42:43], v[162:163] op_sel_hi:[1,0]
    v_pk_mul_f32 v[44:45], v[44:45], v[162:163] op_sel_hi:[1,0]
    v_pk_mul_f32 v[46:47], v[46:47], v[162:163] op_sel_hi:[1,0]
    v_pk_mul_f32 v[48:49], v[48:49], v[162:163] op_sel_hi:[1,0]
    v_pk_mul_f32 v[50:51], v[50:51], v[162:163] op_sel_hi:[1,0]
    v_pk_mul_f32 v[52:53], v[52:53], v[162:163] op_sel_hi:[1,0]
    v_pk_mul_f32 v[54:55], v[54:55], v[162:163] op_sel_hi:[1,0]
    v_pk_mul_f32 v[56:57], v[56:57], v[162:163] op_sel_hi:[1,0]
    v_pk_mul_f32 v[58:59], v[58:59], v[162:163] op_sel_hi:[1,0]
    v_pk_mul_f32 v[60:61], v[60:61], v[162:163] op_sel_hi:[1,0]
    v_pk_mul_f32 v[62:63], v[62:63], v[162:163] op_sel_hi:[1,0]
    s_mov_b64 exec, 0xffff
L_opoll:
    s_waitcnt vmcnt(0)
    v_cmp_eq_u32 vcc, -1, v64
    s_nop 0
    s_and_b64 exec, exec, vcc
    s_cbranch_execz L_ordy
    s_sleep 1
    buffer_load_dword v64, v65, s[44:47], 0 offen sc1
    s_branch L_opoll
L_ordy:
    s_mov_b64 exec, -1
    buffer_load_dwordx4 v[64:67], v160, s[44:47], 0 offen offset:0 sc1
    buffer_load_dwordx4 v[68:71], v160, s[44:47], s55 offen offset:0 sc1
    buffer_load_dwordx4 v[72:75], v160, s[44:47], 0 offen offset:1024 sc1
    buffer_load_dwordx4 v[76:79], v160, s[44:47], s55 offen offset:1024 sc1
    buffer_load_dwordx4 v[80:83], v160, s[44:47], 0 offen offset:2048 sc1
    buffer_load_dwordx4 v[84:87], v160, s[44:47], s55 offen offset:2048 sc1
    buffer_load_dwordx4 v[88:91], v160, s[44:47], 0 offen offset:3072 sc1
    buffer_load_dwordx4 v[92:95], v160, s[44:47], s55 offen offset:3072 sc1
    buffer_load_dwordx4 v[96:99], v160, s[44:47], s54 offen offset:0 sc1
    buffer_load_dwordx4 v[100:103], v160, s[44:47], s56 offen offset:0 sc1
    buffer_load_dwordx4 v[104:107], v160, s[44:47], s54 offen offset:1024 sc1
    buffer_load_dwordx4 v[108:111], v160, s[44:47], s56 offen offset:1024 sc1
    buffer_load_dwordx4 v[112:115], v160, s[44:47], s54 offen offset:2048 sc1
    buffer_load_dwordx4 v[116:119], v160, s[44:47], s56 offen offset:2048 sc1
    buffer_load_dwordx4 v[120:123], v160, s[44:47], s54 offen offset:3072 sc1
    buffer_load_dwordx4 v[124:127], v160, s[44:47], s56 offen offset:3072 sc1
    s_waitcnt vmcnt(14)
    v_max3_u32 v166, v64, v65, v66
    v_max3_u32 v167, v67, v68, v69
    v_max3_u32 v166, v70, v71, v166
    v_max_u32 v166, v166, v167
    v_cmp_eq_u32 vcc, -1, v166
    s_bitset1_b32 s57, 0
    s_cbranch_vccnz L_op0
    s_bitset0_b32 s57, 0
    v_mfma_f32_32x32x16_bf16 v[0:15], v[128:131], v[64:67], v[0:15]
    v_mfma_f32_32x32x16_bf16 v[32:47], v[128:131], v[68:71], v[32:47]
    v_mfma_f32_32x32x16_bf16 v[16:31], v[132:135], v[64:67], v[16:31]
    v_mfma_f32_32x32x16_bf16 v[48:63], v[132:135], v[68:71], v[48:63]
L_op0:
    ds_read_b64_tr_b16 v[128:129], v163 offset:8192
    ds_read_b64_tr_b16 v[130:131], v163 offset:9216
    ds_read_b64_tr_b16 v[132:133], v164 offset:8192
    ds_read_b64_tr_b16 v[134:135], v164 offset:9216
    s_waitcnt vmcnt(12)
    v_max3_u32 v166, v72, v73, v74
    v_max3_u32 v167, v75, v76, v77
    v_max3_u32 v166, v78, v79, v166
    v_max_u32 v166, v166, v167
    v_cmp_eq_u32 vcc, -1, v166
    s_bitset1_b32 s57, 1
    s_cbranch_vccnz L_op1
    s_bitset0_b32 s57, 1
    v_mfma_f32_32x32x16_bf16 v[0:15], v[136:139], v[72:75], v[0:15]
    v_mfma_f32_32x32x16_bf16 v[32:47], v[136:139], v[76:79], v[32:47]
    v_mfma_f32_32x32x16_bf16 v[16:31], v[140:143], v[72:75], v[16:31]
    v_mfma_f32_32x32x16_bf16 v[48:63], v[140:143], v[76:79], v[48:63]
L_op1:
    ds_read_b64_tr_b16 v[136:137], v163 offset:10240
    ds_read_b64_tr_b16 v[138:139], v163 offset:11264
    ds_read_b64_tr_b16 v[140:141], v164 offset:10240
    ds_read_b64_tr_b16 v[142:143], v164 offset:11264
    s_waitcnt vmcnt(10)
    v_max3_u32 v166, v80, v81, v82
    v_max3_u32 v167, v83, v84, v85
    v_max3_u32 v166, v86, v87, v166
    v_max_u32 v166, v166, v167
    v_cmp_eq_u32 vcc, -1, v166
    s_bitset1_b32 s57, 2
    s_cbranch_vccnz L_op2
    s_bitset0_b32 s57, 2
    v_mfma_f32_32x32x16_bf16 v[0:15], v[144:147], v[80:83], v[0:15]
    v_mfma_f32_32x32x16_bf16 v[32:47], v[144:147], v[84:87], v[32:47]
    v_mfma_f32_32x32x16_bf16 v[16:31], v[148:151], v[80:83], v[16:31]
    v_mfma_f32_32x32x16_bf16 v[48:63], v[148:151], v[84:87], v[48:63]
L_op2:
    ds_read_b64_tr_b16 v[144:145], v163 offset:12288
    ds_read_b64_tr_b16 v[146:147], v163 offset:13312
    ds_read_b64_tr_b16 v[148:149], v164 offset:12288
    ds_read_b64_tr_b16 v[150:151], v164 offset:13312
    s_waitcnt vmcnt(8)
    v_max3_u32 v166, v88, v89, v90
    v_max3_u32 v167, v91, v92, v93
    v_max3_u32 v166, v94, v95, v166
    v_max_u32 v166, v166, v167
    v_cmp_eq_u32 vcc, -1, v166
    s_bitset1_b32 s57, 3
    s_cbranch_vccnz L_op3
    s_bitset0_b32 s57, 3
    v_mfma_f32_32x32x16_bf16 v[0:15], v[152:155], v[88:91], v[0:15]
    v_mfma_f32_32x32x16_bf16 v[32:47], v[152:155], v[92:95], v[32:47]
    v_mfma_f32_32x32x16_bf16 v[16:31], v[156:159], v[88:91], v[16:31]
    v_mfma_f32_32x32x16_bf16 v[48:63], v[156:159], v[92:95], v[48:63]
L_op3:
    ds_read_b64_tr_b16 v[152:153], v163 offset:14336
    ds_read_b64_tr_b16 v[154:155], v163 offset:15360
    ds_read_b64_tr_b16 v[156:157], v164 offset:14336
    ds_read_b64_tr_b16 v[158:159], v164 offset:15360
    s_waitcnt vmcnt(6) lgkmcnt(12)
    v_max3_u32 v166, v96, v97, v98
    v_max3_u32 v167, v99, v100, v101
    v_max3_u32 v166, v102, v103, v166
    v_max_u32 v166, v166, v167
    v_cmp_eq_u32 vcc, -1, v166
    s_bitset1_b32 s57, 4
    s_cbranch_vccnz L_op4
    s_bitset0_b32 s57, 4
    v_mfma_f32_32x32x16_bf16 v[0:15], v[128:131], v[96:99], v[0:15]
    v_mfma_f32_32x32x16_bf16 v[32:47], v[128:131], v[100:103], v[32:47]
    v_mfma_f32_32x32x16_bf16 v[16:31], v[132:135], v[96:99], v[16:31]
    v_mfma_f32_32x32x16_bf16 v[48:63], v[132:135], v[100:103], v[48:63]
L_op4:
    s_waitcnt vmcnt(4) lgkmcnt(8)
    v_max3_u32 v166, v104, v105, v106
    v_max3_u32 v167, v107, v108, v109
    v_max3_u32 v166, v110, v111, v166
    v_max_u32 v166, v166, v167
    v_cmp_eq_u32 vcc, -1, v166
    s_bitset1_b32 s57, 5
    s_cbranch_vccnz L_op5
    s_bitset0_b32 s57, 5
    v_mfma_f32_32x32x16_bf16 v[0:15], v[136:139], v[104:107], v[0:15]
    v_mfma_f32_32x32x16_bf16 v[32:47], v[136:139], v[108:111], v[32:47]
    v_mfma_f32_32x32x16_bf16 v[16:31], v[140:143], v[104:107], v[16:31]
    v_mfma_f32_32x32x16_bf16 v[48:63], v[140:143], v[108:111], v[48:63]
L_op5:
    s_waitcnt vmcnt(2) lgkmcnt(4)
    v_max3_u32 v166, v112, v113, v114
    v_max3_u32 v167, v115, v116, v117
    v_max3_u32 v166, v118, v119, v166
    v_max_u32 v166, v166, v167
    v_cmp_eq_u32 vcc, -1, v166
    s_bitset1_b32 s57, 6
    s_cbranch_vccnz L_op6
    s_bitset0_b32 s57, 6
    v_mfma_f32_32x32x16_bf16 v[0:15], v[144:147], v[112:115], v[0:15]
    v_mfma_f32_32x32x16_bf16 v[32:47], v[144:147], v[116:119], v[32:47]
    v_mfma_f32_32x32x16_bf16 v[16:31], v[148:151], v[112:115], v[16:31]
    v_mfma_f32_32x32x16_bf16 v[48:63], v[148:151], v[116:119], v[48:63]
L_op6:
    s_waitcnt vmcnt(0) lgkmcnt(0)
    v_max3_u32 v166, v120, v121, v122
    v_max3_u32 v167, v123, v124, v125
    v_max3_u32 v166, v126, v127, v166
    v_max_u32 v166, v166, v167
    v_cmp_eq_u32 vcc, -1, v166
    s_bitset1_b32 s57, 7
    s_cbranch_vccnz L_op7
    s_bitset0_b32 s57, 7
    v_mfma_f32_32x32x16_bf16 v[0:15], v[152:155], v[120:123], v[0:15]
    v_mfma_f32_32x32x16_bf16 v[32:47], v[152:155], v[124:127], v[32:47]
    v_mfma_f32_32x32x16_bf16 v[16:31], v[156:159], v[120:123], v[16:31]
    v_mfma_f32_32x32x16_bf16 v[48:63], v[156:159], v[124:127], v[48:63]
L_op7:
L_orep:
    s_cmp_eq_u32 s57, 0
    s_cbranch_scc1 L_odone
    s_sleep 1
    s_bitcmp1_b32 s57, 0
    s_cbranch_scc0 L_oi0
    buffer_load_dwordx4 v[64:67], v160, s[44:47], 0 offen offset:0 sc1
    buffer_load_dwordx4 v[68:71], v160, s[44:47], s55 offen offset:0 sc1
L_oi0:
    s_bitcmp1_b32 s57, 1
    s_cbranch_scc0 L_oi1
    buffer_load_dwordx4 v[72:75], v160, s[44:47], 0 offen offset:1024 sc1
    buffer_load_dwordx4 v[76:79], v160, s[44:47], s55 offen offset:1024 sc1
L_oi1:
    s_bitcmp1_b32 s57, 2
    s_cbranch_scc0 L_oi2
    buffer_load_dwordx4 v[80:83], v160, s[44:47], 0 offen offset:2048 sc1
    buffer_load_dwordx4 v[84:87], v160, s[44:47], s55 offen offset:2048 sc1
L_oi2:
    s_bitcmp1_b32 s57, 3
    s_cbranch_scc0 L_oi3
    buffer_load_dwordx4 v[88:91], v160, s[44:47], 0 offen offset:3072 sc1
    buffer_load_dwordx4 v[92:95], v160, s[44:47], s55 offen offset:3072 sc1
L_oi3:
    s_bitcmp1_b32 s57, 4
    s_cbranch_scc0 L_oi4
    buffer_load_dwordx4 v[96:99], v160, s[44:47], s54 offen offset:0 sc1
    buffer_load_dwordx4 v[100:103], v160, s[44:47], s56 offen offset:0 sc1
L_oi4:
    s_bitcmp1_b32 s57, 5
    s_cbranch_scc0 L_oi5
    buffer_load_dwordx4 v[104:107], v160, s[44:47], s54 offen offset:1024 sc1
    buffer_load_dwordx4 v[108:111], v160, s[44:47], s56 offen offset:1024 sc1
L_oi5:
    s_bitcmp1_b32 s57, 6
    s_cbranch_scc0 L_oi6
    buffer_load_dwordx4 v[112:115], v160, s[44:47], s54 offen offset:2048 sc1
    buffer_load_dwordx4 v[116:119], v160, s[44:47], s56 offen offset:2048 sc1
L_oi6:
    s_bitcmp1_b32 s57, 7
    s_cbranch_scc0 L_oi7
    buffer_load_dwordx4 v[120:123], v160, s[44:47], s54 offen offset:3072 sc1
    buffer_load_dwordx4 v[124:127], v160, s[44:47], s56 offen offset:3072 sc1
L_oi7:
    s_waitcnt vmcnt(0)
    s_bitcmp1_b32 s57, 0
    s_cbranch_scc0 L_oq0
    ds_read_b64_tr_b16 v[128:129], v163 offset:0
    ds_read_b64_tr_b16 v[130:131], v163 offset:1024
    ds_read_b64_tr_b16 v[132:133], v164 offset:0
    ds_read_b64_tr_b16 v[134:135], v164 offset:1024
    v_max3_u32 v166, v64, v65, v66
    v_max3_u32 v167, v67, v68, v69
    v_max3_u32 v166, v70, v71, v166
    v_max_u32 v166, v166, v167
    v_cmp_eq_u32 vcc, -1, v166
    s_nop 0
    s_cbranch_vccnz L_oq0
    s_bitset0_b32 s57, 0
    s_waitcnt lgkmcnt(0)
    v_mfma_f32_32x32x16_bf16 v[0:15], v[128:131], v[64:67], v[0:15]
    v_mfma_f32_32x32x16_bf16 v[32:47], v[128:131], v[68:71], v[32:47]
    v_mfma_f32_32x32x16_bf16 v[16:31], v[132:135], v[64:67], v[16:31]
    v_mfma_f32_32x32x16_bf16 v[48:63], v[132:135], v[68:71], v[48:63]
L_oq0:
    s_bitcmp1_b32 s57, 1
    s_cbranch_scc0 L_oq1
    ds_read_b64_tr_b16 v[136:137], v163 offset:2048
    ds_read_b64_tr_b16 v[138:139], v163 offset:3072
    ds_read_b64_tr_b16 v[140:141], v164 offset:2048
    ds_read_b64_tr_b16 v[142:143], v164 offset:3072
    v_max3_u32 v166, v72, v73, v74
    v_max3_u32 v167, v75, v76, v77
    v_max3_u32 v166, v78, v79, v166
    v_max_u32 v166, v166, v167
    v_cmp_eq_u32 vcc, -1, v166
    s_nop 0
    s_cbranch_vccnz L_oq1
    s_bitset0_b32 s57, 1
    s_waitcnt lgkmcnt(0)
    v_mfma_f32_32x32x16_bf16 v[0:15], v[136:139], v[72:75], v[0:15]
    v_mfma_f32_32x32x16_bf16 v[32:47], v[136:139], v[76:79], v[32:47]
    v_mfma_f32_32x32x16_bf16 v[16:31], v[140:143], v[72:75], v[16:31]
    v_mfma_f32_32x32x16_bf16 v[48:63], v[140:143], v[76:79], v[48:63]
L_oq1:
    s_bitcmp1_b32 s57, 2
    s_cbranch_scc0 L_oq2
    ds_read_b64_tr_b16 v[144:145], v163 offset:4096
    ds_read_b64_tr_b16 v[146:147], v163 offset:5120
    ds_read_b64_tr_b16 v[148:149], v164 offset:4096
    ds_read_b64_tr_b16 v[150:151], v164 offset:5120
    v_max3_u32 v166, v80, v81, v82
    v_max3_u32 v167, v83, v84, v85
    v_max3_u32 v166, v86, v87, v166
    v_max_u32 v166, v166, v167
    v_cmp_eq_u32 vcc, -1, v166
    s_nop 0
    s_cbranch_vccnz L_oq2
    s_bitset0_b32 s57, 2
    s_waitcnt lgkmcnt(0)
    v_mfma_f32_32x32x16_bf16 v[0:15], v[144:147], v[80:83], v[0:15]
    v_mfma_f32_32x32x16_bf16 v[32:47], v[144:147], v[84:87], v[32:47]
    v_mfma_f32_32x32x16_bf16 v[16:31], v[148:151], v[80:83], v[16:31]
    v_mfma_f32_32x32x16_bf16 v[48:63], v[148:151], v[84:87], v[48:63]
L_oq2:
    s_bitcmp1_b32 s57, 3
    s_cbranch_scc0 L_oq3
    ds_read_b64_tr_b16 v[152:153], v163 offset:6144
    ds_read_b64_tr_b16 v[154:155], v163 offset:7168
    ds_read_b64_tr_b16 v[156:157], v164 offset:6144
    ds_read_b64_tr_b16 v[158:159], v164 offset:7168
    v_max3_u32 v166, v88, v89, v90
    v_max3_u32 v167, v91, v92, v93
    v_max3_u32 v166, v94, v95, v166
    v_max_u32 v166, v166, v167
    v_cmp_eq_u32 vcc, -1, v166
    s_nop 0
    s_cbranch_vccnz L_oq3
    s_bitset0_b32 s57, 3
    s_waitcnt lgkmcnt(0)
    v_mfma_f32_32x32x16_bf16 v[0:15], v[152:155], v[88:91], v[0:15]
    v_mfma_f32_32x32x16_bf16 v[32:47], v[152:155], v[92:95], v[32:47]
    v_mfma_f32_32x32x16_bf16 v[16:31], v[156:159], v[88:91], v[16:31]
    v_mfma_f32_32x32x16_bf16 v[48:63], v[156:159], v[92:95], v[48:63]
L_oq3:
    s_bitcmp1_b32 s57, 4
    s_cbranch_scc0 L_oq4
    ds_read_b64_tr_b16 v[128:129], v163 offset:8192
    ds_read_b64_tr_b16 v[130:131], v163 offset:9216
    ds_read_b64_tr_b16 v[132:133], v164 offset:8192
    ds_read_b64_tr_b16 v[134:135], v164 offset:9216
    v_max3_u32 v166, v96, v97, v98
    v_max3_u32 v167, v99, v100, v101
    v_max3_u32 v166, v102, v103, v166
    v_max_u32 v166, v166, v167
    v_cmp_eq_u32 vcc, -1, v166
    s_nop 0
    s_cbranch_vccnz L_oq4
    s_bitset0_b32 s57, 4
    s_waitcnt lgkmcnt(0)
    v_mfma_f32_32x32x16_bf16 v[0:15], v[128:131], v[96:99], v[0:15]
    v_mfma_f32_32x32x16_bf16 v[32:47], v[128:131], v[100:103], v[32:47]
    v_mfma_f32_32x32x16_bf16 v[16:31], v[132:135], v[96:99], v[16:31]
    v_mfma_f32_32x32x16_bf16 v[48:63], v[132:135], v[100:103], v[48:63]
L_oq4:
    s_bitcmp1_b32 s57, 5
    s_cbranch_scc0 L_oq5
    ds_read_b64_tr_b16 v[136:137], v163 offset:10240
    ds_read_b64_tr_b16 v[138:139], v163 offset:11264
    ds_read_b64_tr_b16 v[140:141], v164 offset:10240
    ds_read_b64_tr_b16 v[142:143], v164 offset:11264
    v_max3_u32 v166, v104, v105, v106
    v_max3_u32 v167, v107, v108, v109
    v_max3_u32 v166, v110, v111, v166
    v_max_u32 v166, v166, v167
    v_cmp_eq_u32 vcc, -1, v166
    s_nop 0
    s_cbranch_vccnz L_oq5
    s_bitset0_b32 s57, 5
    s_waitcnt lgkmcnt(0)
    v_mfma_f32_32x32x16_bf16 v[0:15], v[136:139], v[104:107], v[0:15]
    v_mfma_f32_32x32x16_bf16 v[32:47], v[136:139], v[108:111], v[32:47]
    v_mfma_f32_32x32x16_bf16 v[16:31], v[140:143], v[104:107], v[16:31]
    v_mfma_f32_32x32x16_bf16 v[48:63], v[140:143], v[108:111], v[48:63]
L_oq5:
    s_bitcmp1_b32 s57, 6
    s_cbranch_scc0 L_oq6
    ds_read_b64_tr_b16 v[144:145], v163 offset:12288
    ds_read_b64_tr_b16 v[146:147], v163 offset:13312
    ds_read_b64_tr_b16 v[148:149], v164 offset:12288
    ds_read_b64_tr_b16 v[150:151], v164 offset:13312
    v_max3_u32 v166, v112, v113, v114
    v_max3_u32 v167, v115, v116, v117
    v_max3_u32 v166, v118, v119, v166
    v_max_u32 v166, v166, v167
    v_cmp_eq_u32 vcc, -1, v166
    s_nop 0
    s_cbranch_vccnz L_oq6
    s_bitset0_b32 s57, 6
    s_waitcnt lgkmcnt(0)
    v_mfma_f32_32x32x16_bf16 v[0:15], v[144:147], v[112:115], v[0:15]
    v_mfma_f32_32x32x16_bf16 v[32:47], v[144:147], v[116:119], v[32:47]
    v_mfma_f32_32x32x16_bf16 v[16:31], v[148:151], v[112:115], v[16:31]
    v_mfma_f32_32x32x16_bf16 v[48:63], v[148:151], v[116:119], v[48:63]
L_oq6:
    s_bitcmp1_b32 s57, 7
    s_cbranch_scc0 L_oq7
    ds_read_b64_tr_b16 v[152:153], v163 offset:14336
    ds_read_b64_tr_b16 v[154:155], v163 offset:15360
    ds_read_b64_tr_b16 v[156:157], v164 offset:14336
    ds_read_b64_tr_b16 v[158:159], v164 offset:15360
    v_max3_u32 v166, v120, v121, v122
    v_max3_u32 v167, v123, v124, v125
    v_max3_u32 v166, v126, v127, v166
    v_max_u32 v166, v166, v167
    v_cmp_eq_u32 vcc, -1, v166
    s_nop 0
    s_cbranch_vccnz L_oq7
    s_bitset0_b32 s57, 7
    s_waitcnt lgkmcnt(0)
    v_mfma_f32_32x32x16_bf16 v[0:15], v[152:155], v[120:123], v[0:15]
    v_mfma_f32_32x32x16_bf16 v[32:47], v[152:155], v[124:127], v[32:47]
    v_mfma_f32_32x32x16_bf16 v[16:31], v[156:159], v[120:123], v[16:31]
    v_mfma_f32_32x32x16_bf16 v[48:63], v[156:159], v[124:127], v[48:63]
L_oq7:
    s_branch L_orep
L_odone:
    v_xor_b32 v64, 0, v161
    v_xor_b32 v65, 32, v161
    v_xor_b32 v66, 64, v161
    v_xor_b32 v67, 96, v161
    v_xor_b32 v68, 128, v161
    v_xor_b32 v69, 160, v161
    v_xor_b32 v70, 192, v161
    v_xor_b32 v71, 224, v161
    s_nop 1
    ds_write_b128 v64, v[0:3] offset:0
    ds_write_b128 v65, v[4:7] offset:0
    ds_write_b128 v66, v[8:11] offset:0
    ds_write_b128 v67, v[12:15] offset:0
    ds_write_b128 v64, v[32:35] offset:8192
    ds_write_b128 v65, v[36:39] offset:8192
    ds_write_b128 v66, v[40:43] offset:8192
    ds_write_b128 v67, v[44:47] offset:8192
    ds_write_b128 v68, v[16:19] offset:0
    ds_write_b128 v69, v[20:23] offset:0
    ds_write_b128 v70, v[24:27] offset:0
    ds_write_b128 v71, v[28:31] offset:0
    ds_write_b128 v68, v[48:51] offset:8192
    ds_write_b128 v69, v[52:55] offset:8192
    ds_write_b128 v70, v[56:59] offset:8192
    ds_write_b128 v71, v[60:63] offset:8192
    s_waitcnt lgkmcnt(0)
    s_barrier
L_end:
L_exit:
    s_endpgm
.section .rodata,"a"
.p2align 6
.amdhsa_kernel gated_mix__softmax_full_mha__dense_activation_squared_relu__prompt_kernel
  .amdhsa_next_free_vgpr 168
  .amdhsa_next_free_sgpr 102
  .amdhsa_accum_offset 168
  .amdhsa_group_segment_fixed_size 0
  .amdhsa_kernarg_size 96
  .amdhsa_user_sgpr_count 2
  .amdhsa_user_sgpr_kernarg_segment_ptr 1
  .amdhsa_system_sgpr_workgroup_id_x 1
.end_amdhsa_kernel
```
